```python
import torch

def _softmax(x, axis=-1):
    return torch.softmax(x, dim=axis)

def _gelu(x):
    return torch.nn.functional.gelu(x, approximate='tanh')

def _silu(x):
    return torch.nn.functional.silu(x)

def _sigmoid(x):
    return torch.sigmoid(x)

def _layernorm(x, axis=-1, eps=1e-05):
    m = x.mean(dim=axis, keepdim=True)
    v = x.var(dim=axis, keepdim=True, unbiased=False)
    return (x - m) / torch.sqrt(v + eps)

def _scatter_add(tgt, idx, src, axis=0):
    return tgt.clone().index_add_(axis, idx, src)

def _segment_sum(src, seg, n):
    out = torch.zeros((n,) + src.shape[1:], dtype=src.dtype)
    return out.index_add_(0, seg, src)

def _pad(x, pw):
    flat = tuple((v for pair in reversed(pw) for v in pair))
    return torch.nn.functional.pad(x, flat)
kernel_name = 'adaLN_cond__sliding_block__glu_gated_geglu__prompt'

def setup_inputs():

    _w = lambda a: (lambda t: t.to(torch.bfloat16) if t.is_floating_point() else t)(torch.as_tensor(a))

    def _A_setup():
        B, S, D = (1, 2048, 640)
        return {'x': _w((lambda *s: torch.randn(*s, dtype=torch.bfloat16) * 0.05)(B, S, D)), 'wqkv': _w((lambda *s: torch.randn(*s, dtype=torch.bfloat16) * 0.05)(D, 3 * D)), 'wo': _w((lambda *s: torch.randn(*s, dtype=torch.bfloat16) * 0.05)(D, D))}
    _A_in = _A_setup()

    def _B_setup():
        B, S, Dm, Df = (1, 2048, 640, 1728)
        return {'x': _w((lambda *s: torch.randn(*s, dtype=torch.bfloat16) * 0.05)(B, S, Dm)), 'w_gate': _w((lambda *s: torch.randn(*s, dtype=torch.bfloat16) * 0.8)(Dm, Df) * Dm ** (-0.5)), 'w_up': _w((lambda *s: torch.randn(*s, dtype=torch.bfloat16) * 0.8)(Dm, Df) * Dm ** (-0.5)), 'w_down': _w((lambda *s: torch.randn(*s, dtype=torch.bfloat16) * 0.8)(Df, Dm) * Df ** (-0.5))}
    _B_in = _B_setup()
    return {'A_x': _A_in['x'], 'A_wqkv': _A_in['wqkv'], 'A_wo': _A_in['wo'], 'B_x': _B_in['x'], 'B_w_gate': _B_in['w_gate'], 'B_w_up': _B_in['w_up'], 'B_w_down': _B_in['w_down'], 'c': _w((lambda *s: torch.randn(*s, dtype=torch.bfloat16) * 0.2)(1, 640) * 8.0), 'w_mod': _w((lambda *s: torch.randn(*s, dtype=torch.bfloat16) * 0.2)(640, 6 * 640) * 640 ** (-0.5) * 8.0)}

def reference(A_x, A_wqkv, A_wo, B_x, B_w_gate, B_w_up, B_w_down, c, w_mod):

    def _A_ref(x, wqkv, wo):
        B, S, D = x.shape
        H = 32
        Dh = D // H
        W = 256
        qkv = (lambda x, *d: x.permute(*d))((x @ wqkv).reshape(B, S, 3, H, Dh), 2, 0, 3, 1, 4)
        q, k, v = (qkv[0], qkv[1], qkv[2])
        scores = torch.einsum('bhqd,bhkd->bhqk', q, k) * Dh ** (-0.5)
        idx = torch.arange(S)
        mask = (idx[:, None] - idx[None, :] >= 0) & (idx[:, None] - idx[None, :] < W)
        scores = torch.where(mask[None, None], scores, -1000000000.0)
        p = _softmax(scores, axis=-1)
        o = torch.einsum('bhqk,bhkd->bhqd', p, v)
        return (lambda x, *d: x.permute(*d))(o, 0, 2, 1, 3).reshape(B, S, D) @ wo

    def _B_ref(x, w_gate, w_up, w_down):
        g = torch.einsum('bsd,df->bsf', x, w_gate)
        u = torch.einsum('bsd,df->bsf', x, w_up)
        h = _gelu(g) * u
        return torch.einsum('bsf,fd->bsd', h, w_down)
    x = A_x
    mod = (_silu(c) @ w_mod).reshape(c.shape[0], 6, 1, -1)
    sa, ca, ga, sb, cb, gb = (mod[:, 0].clone(), mod[:, 1].clone(), mod[:, 2].clone(), mod[:, 3].clone(), mod[:, 4].clone(), mod[:, 5].clone())
    h = _layernorm(x, axis=-1) * (1 + ca) + sa
    x = x + ga * _A_ref(h, A_wqkv, A_wo)
    h = _layernorm(x, axis=-1) * (1 + cb) + sb
    x = x + gb * _B_ref(h, B_w_gate, B_w_up, B_w_down)
    return x
```

```asm
; @launch grid=(256,1,1) block=(512,1,1) lds=163840
.amdgcn_target "amdgcn-amd-amdhsa--gfx950"
.text
.globl adaLN_cond__sliding_block__glu_gated_geglu__prompt_kernel
.p2align 8
.type adaLN_cond__sliding_block__glu_gated_geglu__prompt_kernel,@function
adaLN_cond__sliding_block__glu_gated_geglu__prompt_kernel:
  s_cmp_ge_u32 s2, 256
  s_cbranch_scc1 L_END
  s_load_dwordx4 s[4:7], s[0:1], 0
  s_load_dwordx2 s[8:9], s[0:1], 16
  s_load_dwordx4 s[12:15], s[0:1], 32
  s_load_dwordx4 s[16:19], s[0:1], 48
  s_load_dwordx4 s[20:23], s[0:1], 64
  s_load_dwordx2 s[10:11], s[0:1], 88
  v_and_b32 v1, 63, v0
  v_lshrrev_b32 v2, 6, v0
  s_nop 0
  v_readfirstlane_b32 s43, v2
  s_and_b32 s40, s2, 7
  s_lshr_b32 s41, s2, 3
  s_waitcnt lgkmcnt(0)
  s_load_dword s42, s[10:11], 131072
  s_mov_b32 s24, s10
  s_mov_b32 s25, s11
  s_mov_b32 s26, 268435456
  s_mov_b32 s27, 0x20000
  s_lshr_b32 s44, s40, 2
  s_lshl_b32 s44, s44, 2
  s_and_b32 s45, s41, 3
  s_add_u32 s52, s44, s45
  s_and_b32 s44, s40, 3
  s_lshl_b32 s44, s44, 3
  s_lshr_b32 s45, s41, 2
  s_add_u32 s53, s44, s45
  s_sub_u32 s44, 11, s43
  s_cmp_lt_u32 s43, 4
  s_cselect_b32 s54, s43, s44
  s_lshl_b32 s44, s2, 3
  s_add_u32 s44, s44, s43
  s_mul_i32 s45, s44, 1280
  s_add_u32 s28, s4, s45
  s_addc_u32 s29, s5, 0
  s_mov_b32 s30, 1280
  s_mov_b32 s31, 0x20000
  v_lshlrev_b32 v2, 4, v1
  buffer_load_dwordx4 v[8:11], v2, s[28:31], 0 offen
  buffer_load_dwordx4 v[12:15], v2, s[28:31], 0 offen offset:1024
  s_mul_i32 s46, s40, 15
  s_add_u32 s46, s46, s41
  s_cmp_ge_u32 s41, 15
  s_cbranch_scc1 L_nogemv_1
  s_lshr_b32 s48, s46, 1
  s_lshl_b32 s48, s48, 7
  s_add_u32 s32, s20, s48
  s_addc_u32 s33, s21, 0
  s_mov_b32 s34, 4915200
  s_mov_b32 s35, 0x20000
  s_sub_u32 s34, s34, s48
  s_mov_b32 s36, s18
  s_mov_b32 s37, s19
  s_mov_b32 s38, 1280
  s_mov_b32 s39, 0x20000
  s_and_b32 s49, s46, 1
  s_mul_i32 s49, s49, 320
  s_mul_i32 s50, s43, 40
  s_add_u32 s49, s49, s50
  v_lshrrev_b32 v3, 3, v1
  v_add_u32 v3, s49, v3
  v_lshlrev_b32 v4, 1, v3
  s_movk_i32 s49, 7680
  v_mul_lo_u32 v5, v3, s49
  v_and_b32 v6, 7, v1
  v_lshl_add_u32 v5, v6, 4, v5
  buffer_load_ushort v48, v4, s[36:39], 0 offen offset:0
  buffer_load_ushort v49, v4, s[36:39], 0 offen offset:16
  buffer_load_ushort v50, v4, s[36:39], 0 offen offset:32
  buffer_load_ushort v51, v4, s[36:39], 0 offen offset:48
  buffer_load_ushort v52, v4, s[36:39], 0 offen offset:64
  s_mov_b32 s49, 0
  buffer_load_dwordx4 v[76:79], v5, s[32:35], s49 offen
  s_mov_b32 s49, 61440
  buffer_load_dwordx4 v[80:83], v5, s[32:35], s49 offen
  s_mov_b32 s49, 122880
  buffer_load_dwordx4 v[84:87], v5, s[32:35], s49 offen
  s_mov_b32 s49, 184320
  buffer_load_dwordx4 v[88:91], v5, s[32:35], s49 offen
  s_mov_b32 s49, 245760
  buffer_load_dwordx4 v[92:95], v5, s[32:35], s49 offen
L_nogemv_1:
  v_and_b32 v72, 15, v1
  v_lshrrev_b32 v73, 4, v1
  v_mov_b32 v74, 0
  v_mov_b32 v75, 8
  v_cmp_eq_u32 vcc, 1, v72
  s_nop 1
  v_cndmask_b32 v74, v74, v75, vcc
  v_mov_b32 v75, 16
  v_cmp_eq_u32 vcc, 2, v72
  s_nop 1
  v_cndmask_b32 v74, v74, v75, vcc
  v_mov_b32 v75, 24
  v_cmp_eq_u32 vcc, 3, v72
  s_nop 1
  v_cndmask_b32 v74, v74, v75, vcc
  v_mov_b32 v75, 32
  v_cmp_eq_u32 vcc, 4, v72
  s_nop 1
  v_cndmask_b32 v74, v74, v75, vcc
  v_mov_b32 v75, 2560
  v_cmp_eq_u32 vcc, 5, v72
  s_nop 1
  v_cndmask_b32 v74, v74, v75, vcc
  v_mov_b32 v75, 2568
  v_cmp_eq_u32 vcc, 6, v72
  s_nop 1
  v_cndmask_b32 v74, v74, v75, vcc
  v_mov_b32 v75, 2576
  v_cmp_eq_u32 vcc, 7, v72
  s_nop 1
  v_cndmask_b32 v74, v74, v75, vcc
  v_mov_b32 v75, 1280
  v_cmp_eq_u32 vcc, 8, v72
  s_nop 1
  v_cndmask_b32 v74, v74, v75, vcc
  v_mov_b32 v75, 1288
  v_cmp_eq_u32 vcc, 9, v72
  s_nop 1
  v_cndmask_b32 v74, v74, v75, vcc
  v_mov_b32 v75, 1296
  v_cmp_eq_u32 vcc, 10, v72
  s_nop 1
  v_cndmask_b32 v74, v74, v75, vcc
  v_mov_b32 v75, 1304
  v_cmp_eq_u32 vcc, 11, v72
  s_nop 1
  v_cndmask_b32 v74, v74, v75, vcc
  v_mov_b32 v75, 1312
  v_cmp_eq_u32 vcc, 12, v72
  s_nop 1
  v_cndmask_b32 v74, v74, v75, vcc
  v_mov_b32 v75, 2584
  v_cmp_eq_u32 vcc, 13, v72
  s_nop 1
  v_cndmask_b32 v74, v74, v75, vcc
  v_mov_b32 v75, 2592
  v_cmp_eq_u32 vcc, 14, v72
  s_nop 1
  v_cndmask_b32 v74, v74, v75, vcc
  v_mov_b32 v75, 2592
  v_cmp_eq_u32 vcc, 15, v72
  s_nop 1
  v_cndmask_b32 v74, v74, v75, vcc
  s_lshr_b32 s44, s40, 2
  s_mul_i32 s44, s44, 320
  s_sub_u32 s45, s41, 16
  s_mul_i32 s45, s45, 20
  s_add_u32 s44, s44, s45
  s_lshr_b32 s45, s43, 1
  s_mul_i32 s45, s45, 5
  s_add_u32 s44, s44, s45
  s_and_b32 s45, s40, 3
  s_lshl_b32 s45, s45, 3
  s_and_b32 s47, s43, 1
  s_lshl_b32 s47, s47, 2
  s_add_u32 s45, s45, s47
  v_add_u32 v73, s45, v73
  v_mul_u32_u24 v75, 40, v73
  v_add_u32 v74, v74, v75
  s_mov_b32 s47, 81920
  v_mul_lo_u32 v73, v73, s47
  v_lshl_add_u32 v73, v72, 3, v73
  s_lshl_b32 s72, s44, 7
  s_add_u32 s72, s72, 27262976
  s_mul_i32 s44, s44, 3840
  s_mov_b32 s28, s6
  s_mov_b32 s29, s7
  s_mov_b32 s30, 2457600
  s_mov_b32 s31, 0x20000
  s_cmp_lt_u32 s41, 16
  s_cbranch_scc1 L_nog_2
  buffer_load_dwordx2 v[60:61], v74, s[28:31], s44 offen
  s_add_u32 s44, s44, 3840
  buffer_load_dwordx2 v[62:63], v74, s[28:31], s44 offen
  s_add_u32 s44, s44, 3840
  buffer_load_dwordx2 v[64:65], v74, s[28:31], s44 offen
  s_add_u32 s44, s44, 3840
  buffer_load_dwordx2 v[66:67], v74, s[28:31], s44 offen
  s_add_u32 s44, s44, 3840
  buffer_load_dwordx2 v[68:69], v74, s[28:31], s44 offen
L_nog_2:
  s_cmp_lt_u32 s41, 15
  s_cbranch_scc1 L_wx_3
  s_cmp_eq_u32 s41, 15
  s_cbranch_scc1 L_wx_5
  s_waitcnt vmcnt(5)
  s_branch L_wx_4
L_wx_5:
  s_waitcnt vmcnt(0)
  s_branch L_wx_4
L_wx_3:
  s_waitcnt vmcnt(10)
L_wx_4:
  v_lshlrev_b32 v16, 16, v8
  v_and_b32 v17, 0xffff0000, v8
  v_lshlrev_b32 v18, 16, v9
  v_and_b32 v19, 0xffff0000, v9
  v_lshlrev_b32 v20, 16, v10
  v_and_b32 v21, 0xffff0000, v10
  v_lshlrev_b32 v22, 16, v11
  v_and_b32 v23, 0xffff0000, v11
  v_lshlrev_b32 v24, 16, v12
  v_and_b32 v25, 0xffff0000, v12
  v_lshlrev_b32 v26, 16, v13
  v_and_b32 v27, 0xffff0000, v13
  v_lshlrev_b32 v28, 16, v14
  v_and_b32 v29, 0xffff0000, v14
  v_lshlrev_b32 v30, 16, v15
  v_and_b32 v31, 0xffff0000, v15
  v_add_f32 v32, v16, v17
  v_mul_f32 v33, v16, v16
  v_fmac_f32 v33, v17, v17
  v_add_f32 v32, v32, v18
  v_fmac_f32 v33, v18, v18
  v_add_f32 v32, v32, v19
  v_fmac_f32 v33, v19, v19
  v_add_f32 v32, v32, v20
  v_fmac_f32 v33, v20, v20
  v_add_f32 v32, v32, v21
  v_fmac_f32 v33, v21, v21
  v_add_f32 v32, v32, v22
  v_fmac_f32 v33, v22, v22
  v_add_f32 v32, v32, v23
  v_fmac_f32 v33, v23, v23
  v_add_f32 v32, v32, v24
  v_fmac_f32 v33, v24, v24
  v_add_f32 v32, v32, v25
  v_fmac_f32 v33, v25, v25
  v_add_f32 v32, v32, v26
  v_fmac_f32 v33, v26, v26
  v_add_f32 v32, v32, v27
  v_fmac_f32 v33, v27, v27
  v_add_f32 v32, v32, v28
  v_fmac_f32 v33, v28, v28
  v_add_f32 v32, v32, v29
  v_fmac_f32 v33, v29, v29
  v_add_f32 v32, v32, v30
  v_fmac_f32 v33, v30, v30
  v_add_f32 v32, v32, v31
  v_fmac_f32 v33, v31, v31
  s_nop 0
  v_add_f32_dpp v32, v32, v32 row_shr:1 row_mask:0xf bank_mask:0xf bound_ctrl:0
  v_add_f32_dpp v33, v33, v33 row_shr:1 row_mask:0xf bank_mask:0xf bound_ctrl:0
  s_nop 0
  v_add_f32_dpp v32, v32, v32 row_shr:2 row_mask:0xf bank_mask:0xf bound_ctrl:0
  v_add_f32_dpp v33, v33, v33 row_shr:2 row_mask:0xf bank_mask:0xf bound_ctrl:0
  s_nop 0
  v_add_f32_dpp v32, v32, v32 row_shr:4 row_mask:0xf bank_mask:0xf bound_ctrl:0
  v_add_f32_dpp v33, v33, v33 row_shr:4 row_mask:0xf bank_mask:0xf bound_ctrl:0
  s_nop 0
  v_add_f32_dpp v32, v32, v32 row_shr:8 row_mask:0xf bank_mask:0xf bound_ctrl:0
  v_add_f32_dpp v33, v33, v33 row_shr:8 row_mask:0xf bank_mask:0xf bound_ctrl:0
  s_nop 0
  v_add_f32_dpp v32, v32, v32 row_bcast:15 row_mask:0xa bank_mask:0xf
  v_add_f32_dpp v33, v33, v33 row_bcast:15 row_mask:0xa bank_mask:0xf
  s_nop 0
  v_add_f32_dpp v32, v32, v32 row_bcast:31 row_mask:0xc bank_mask:0xf
  v_add_f32_dpp v33, v33, v33 row_bcast:31 row_mask:0xc bank_mask:0xf
  v_readlane_b32 s50, v32, 63
  v_readlane_b32 s51, v33, 63
  v_mov_b32 v34, 0x3acccccd
  v_mul_f32 v32, s50, v34
  v_mul_f32 v33, s51, v34
  v_fma_f32 v33, -v32, v32, v33
  v_max_f32 v33, 0, v33
  v_add_f32 v33, 0x3727c5ac, v33
  v_rsq_f32 v33, v33
  v_sub_f32 v16, v16, v32
  v_sub_f32 v17, v17, v32
  v_sub_f32 v18, v18, v32
  v_sub_f32 v19, v19, v32
  v_sub_f32 v20, v20, v32
  v_sub_f32 v21, v21, v32
  v_sub_f32 v22, v22, v32
  v_sub_f32 v23, v23, v32
  v_sub_f32 v24, v24, v32
  v_sub_f32 v25, v25, v32
  v_sub_f32 v26, v26, v32
  v_sub_f32 v27, v27, v32
  v_sub_f32 v28, v28, v32
  v_sub_f32 v29, v29, v32
  v_sub_f32 v30, v30, v32
  v_sub_f32 v31, v31, v32
  v_mul_f32 v16, v16, v33
  v_mul_f32 v17, v17, v33
  v_mul_f32 v18, v18, v33
  v_mul_f32 v19, v19, v33
  v_mul_f32 v20, v20, v33
  v_mul_f32 v21, v21, v33
  v_mul_f32 v22, v22, v33
  v_mul_f32 v23, v23, v33
  v_mul_f32 v24, v24, v33
  v_mul_f32 v25, v25, v33
  v_mul_f32 v26, v26, v33
  v_mul_f32 v27, v27, v33
  v_mul_f32 v28, v28, v33
  v_mul_f32 v29, v29, v33
  v_mul_f32 v30, v30, v33
  v_mul_f32 v31, v31, v33
  v_cvt_pk_bf16_f32 v8, v16, v17
  v_cvt_pk_bf16_f32 v9, v18, v19
  v_cvt_pk_bf16_f32 v10, v20, v21
  v_cvt_pk_bf16_f32 v11, v22, v23
  v_cvt_pk_bf16_f32 v12, v24, v25
  v_cvt_pk_bf16_f32 v13, v26, v27
  v_cvt_pk_bf16_f32 v14, v28, v29
  v_cvt_pk_bf16_f32 v15, v30, v31
  s_mul_i32 s50, s43, 1296
  v_add_u32 v35, s50, v2
  ds_write_b128 v35, v[8:11] offset:0
  s_mov_b32 exec_lo, 65535
  s_mov_b32 exec_hi, 0
  ds_write_b128 v35, v[12:15] offset:1024
  s_mov_b64 exec, -1
  s_cmp_ge_u32 s41, 15
  s_cbranch_scc1 L_nogemv_6
  s_waitcnt vmcnt(5)
  v_lshlrev_b32 v48, 16, v48
  v_mul_f32 v36, 0xbfb8aa3b, v48
  v_exp_f32 v36, v36
  s_nop 0
  v_add_f32 v36, 1.0, v36
  v_rcp_f32 v36, v36
  s_nop 0
  v_mul_f32 v48, v48, v36
  v_cvt_pk_bf16_f32 v48, v48, v48
  v_and_b32 v48, 0xffff0000, v48
  v_lshlrev_b32 v49, 16, v49
  v_mul_f32 v36, 0xbfb8aa3b, v49
  v_exp_f32 v36, v36
  s_nop 0
  v_add_f32 v36, 1.0, v36
  v_rcp_f32 v36, v36
  s_nop 0
  v_mul_f32 v49, v49, v36
  v_cvt_pk_bf16_f32 v49, v49, v49
  v_and_b32 v49, 0xffff0000, v49
  v_lshlrev_b32 v50, 16, v50
  v_mul_f32 v36, 0xbfb8aa3b, v50
  v_exp_f32 v36, v36
  s_nop 0
  v_add_f32 v36, 1.0, v36
  v_rcp_f32 v36, v36
  s_nop 0
  v_mul_f32 v50, v50, v36
  v_cvt_pk_bf16_f32 v50, v50, v50
  v_and_b32 v50, 0xffff0000, v50
  v_lshlrev_b32 v51, 16, v51
  v_mul_f32 v36, 0xbfb8aa3b, v51
  v_exp_f32 v36, v36
  s_nop 0
  v_add_f32 v36, 1.0, v36
  v_rcp_f32 v36, v36
  s_nop 0
  v_mul_f32 v51, v51, v36
  v_cvt_pk_bf16_f32 v51, v51, v51
  v_and_b32 v51, 0xffff0000, v51
  v_lshlrev_b32 v52, 16, v52
  v_mul_f32 v36, 0xbfb8aa3b, v52
  v_exp_f32 v36, v36
  s_nop 0
  v_add_f32 v36, 1.0, v36
  v_rcp_f32 v36, v36
  s_nop 0
  v_mul_f32 v52, v52, v36
  v_cvt_pk_bf16_f32 v52, v52, v52
  v_and_b32 v52, 0xffff0000, v52
  s_waitcnt vmcnt(4)
  v_lshlrev_b32 v36, 16, v76
  v_and_b32 v37, 0xffff0000, v76
  v_mul_f32 v40, v48, v36
  v_mul_f32 v41, v48, v37
  v_lshlrev_b32 v36, 16, v77
  v_and_b32 v37, 0xffff0000, v77
  v_mul_f32 v42, v48, v36
  v_mul_f32 v43, v48, v37
  v_lshlrev_b32 v36, 16, v78
  v_and_b32 v37, 0xffff0000, v78
  v_mul_f32 v44, v48, v36
  v_mul_f32 v45, v48, v37
  v_lshlrev_b32 v36, 16, v79
  v_and_b32 v37, 0xffff0000, v79
  v_mul_f32 v46, v48, v36
  v_mul_f32 v47, v48, v37
  s_waitcnt vmcnt(3)
  v_lshlrev_b32 v36, 16, v80
  v_and_b32 v37, 0xffff0000, v80
  v_fmac_f32 v40, v49, v36
  v_fmac_f32 v41, v49, v37
  v_lshlrev_b32 v36, 16, v81
  v_and_b32 v37, 0xffff0000, v81
  v_fmac_f32 v42, v49, v36
  v_fmac_f32 v43, v49, v37
  v_lshlrev_b32 v36, 16, v82
  v_and_b32 v37, 0xffff0000, v82
  v_fmac_f32 v44, v49, v36
  v_fmac_f32 v45, v49, v37
  v_lshlrev_b32 v36, 16, v83
  v_and_b32 v37, 0xffff0000, v83
  v_fmac_f32 v46, v49, v36
  v_fmac_f32 v47, v49, v37
  s_waitcnt vmcnt(2)
  v_lshlrev_b32 v36, 16, v84
  v_and_b32 v37, 0xffff0000, v84
  v_fmac_f32 v40, v50, v36
  v_fmac_f32 v41, v50, v37
  v_lshlrev_b32 v36, 16, v85
  v_and_b32 v37, 0xffff0000, v85
  v_fmac_f32 v42, v50, v36
  v_fmac_f32 v43, v50, v37
  v_lshlrev_b32 v36, 16, v86
  v_and_b32 v37, 0xffff0000, v86
  v_fmac_f32 v44, v50, v36
  v_fmac_f32 v45, v50, v37
  v_lshlrev_b32 v36, 16, v87
  v_and_b32 v37, 0xffff0000, v87
  v_fmac_f32 v46, v50, v36
  v_fmac_f32 v47, v50, v37
  s_waitcnt vmcnt(1)
  v_lshlrev_b32 v36, 16, v88
  v_and_b32 v37, 0xffff0000, v88
  v_fmac_f32 v40, v51, v36
  v_fmac_f32 v41, v51, v37
  v_lshlrev_b32 v36, 16, v89
  v_and_b32 v37, 0xffff0000, v89
  v_fmac_f32 v42, v51, v36
  v_fmac_f32 v43, v51, v37
  v_lshlrev_b32 v36, 16, v90
  v_and_b32 v37, 0xffff0000, v90
  v_fmac_f32 v44, v51, v36
  v_fmac_f32 v45, v51, v37
  v_lshlrev_b32 v36, 16, v91
  v_and_b32 v37, 0xffff0000, v91
  v_fmac_f32 v46, v51, v36
  v_fmac_f32 v47, v51, v37
  s_waitcnt vmcnt(0)
  v_lshlrev_b32 v36, 16, v92
  v_and_b32 v37, 0xffff0000, v92
  v_fmac_f32 v40, v52, v36
  v_fmac_f32 v41, v52, v37
  v_lshlrev_b32 v36, 16, v93
  v_and_b32 v37, 0xffff0000, v93
  v_fmac_f32 v42, v52, v36
  v_fmac_f32 v43, v52, v37
  v_lshlrev_b32 v36, 16, v94
  v_and_b32 v37, 0xffff0000, v94
  v_fmac_f32 v44, v52, v36
  v_fmac_f32 v45, v52, v37
  v_lshlrev_b32 v36, 16, v95
  v_and_b32 v37, 0xffff0000, v95
  v_fmac_f32 v46, v52, v36
  v_fmac_f32 v47, v52, v37
  v_add_f32_dpp v40, v40, v40 row_shr:8 row_mask:0xf bank_mask:0xf bound_ctrl:0
  v_add_f32_dpp v41, v41, v41 row_shr:8 row_mask:0xf bank_mask:0xf bound_ctrl:0
  v_add_f32_dpp v42, v42, v42 row_shr:8 row_mask:0xf bank_mask:0xf bound_ctrl:0
  v_add_f32_dpp v43, v43, v43 row_shr:8 row_mask:0xf bank_mask:0xf bound_ctrl:0
  v_add_f32_dpp v44, v44, v44 row_shr:8 row_mask:0xf bank_mask:0xf bound_ctrl:0
  v_add_f32_dpp v45, v45, v45 row_shr:8 row_mask:0xf bank_mask:0xf bound_ctrl:0
  v_add_f32_dpp v46, v46, v46 row_shr:8 row_mask:0xf bank_mask:0xf bound_ctrl:0
  v_add_f32_dpp v47, v47, v47 row_shr:8 row_mask:0xf bank_mask:0xf bound_ctrl:0
  s_lshl_b32 s50, s43, 10
  v_lshrrev_b32 v36, 4, v1
  v_lshlrev_b32 v36, 8, v36
  v_and_b32 v37, 7, v1
  v_lshl_add_u32 v36, v37, 5, v36
  v_add_u32 v36, s50, v36
  s_mov_b32 exec_lo, 0xff00ff00
  s_mov_b32 exec_hi, 0xff00ff00
  ds_write_b128 v36, v[40:43] offset:12288
  ds_write_b128 v36, v[44:47] offset:12304
  s_mov_b64 exec, -1
L_nogemv_6:
  s_waitcnt lgkmcnt(0)
  s_barrier
  s_waitcnt vmcnt(0)
  s_cmp_lt_u32 s41, 16
  s_cbranch_scc1 L_ngs_7
  buffer_store_dwordx2 v[60:61], v73, s[24:27], s72 offen offset:0 sc0 sc1
  buffer_store_dwordx2 v[62:63], v73, s[24:27], s72 offen offset:128 sc0 sc1
  buffer_store_dwordx2 v[64:65], v73, s[24:27], s72 offen offset:256 sc0 sc1
  buffer_store_dwordx2 v[66:67], v73, s[24:27], s72 offen offset:384 sc0 sc1
  buffer_store_dwordx2 v[68:69], v73, s[24:27], s72 offen offset:512 sc0 sc1
L_ngs_7:
  v_and_b32 v2, 7, v1
  v_lshrrev_b32 v3, 3, v1
  s_movk_i32 s50, 1296
  v_mul_lo_u32 v4, v2, s50
  v_lshl_add_u32 v4, v3, 4, v4
  s_lshl_b32 s50, s43, 7
  v_add_u32 v4, s50, v4
  s_lshr_b32 s50, s2, 1
  s_mul_i32 s50, s50, 20480
  s_and_b32 s51, s2, 1
  s_lshl_b32 s51, s51, 7
  s_add_u32 s50, s50, s51
  s_lshl_b32 s51, s43, 11
  s_add_u32 s50, s50, s51
  s_add_u32 s50, s50, 1048576
  v_lshrrev_b32 v5, 2, v3
  v_lshlrev_b32 v5, 10, v5
  v_and_b32 v6, 3, v3
  v_lshl_add_u32 v5, v6, 8, v5
  v_lshl_add_u32 v5, v2, 4, v5
  ds_read_b128 v[8:11], v4 offset:0
  s_cmp_ge_u32 s43, 2
  s_cbranch_scc1 L_x2_8
  ds_read_b128 v[12:15], v4 offset:1024
  s_add_u32 s51, s50, 16384
  s_waitcnt lgkmcnt(0)
  buffer_store_dwordx4 v[12:15], v5, s[24:27], s51 offen sc0 sc1
  s_nop 1
L_x2_8:
  s_waitcnt lgkmcnt(0)
  buffer_store_dwordx4 v[8:11], v5, s[24:27], s50 offen sc0 sc1
  s_cmp_lg_u32 s43, 7
  s_nop 0
  s_cbranch_scc1 L_nomod_9
  s_cmp_ge_u32 s41, 15
  s_cbranch_scc1 L_nomod_9
  v_lshlrev_b32 v18, 2, v1
  ds_read_b32 v16, v18 offset:12288
  ds_read_b32 v17, v18 offset:12544
  ds_read_b32 v20, v18 offset:12800
  ds_read_b32 v21, v18 offset:13056
  ds_read_b32 v22, v18 offset:13312
  ds_read_b32 v23, v18 offset:13568
  ds_read_b32 v24, v18 offset:13824
  ds_read_b32 v25, v18 offset:14080
  ds_read_b32 v26, v18 offset:14336
  ds_read_b32 v27, v18 offset:14592
  ds_read_b32 v28, v18 offset:14848
  ds_read_b32 v29, v18 offset:15104
  ds_read_b32 v30, v18 offset:15360
  ds_read_b32 v31, v18 offset:15616
  ds_read_b32 v32, v18 offset:15872
  ds_read_b32 v33, v18 offset:16128
  ds_read_b32 v34, v18 offset:16384
  ds_read_b32 v35, v18 offset:16640
  ds_read_b32 v36, v18 offset:16896
  ds_read_b32 v37, v18 offset:17152
  ds_read_b32 v38, v18 offset:17408
  ds_read_b32 v39, v18 offset:17664
  ds_read_b32 v40, v18 offset:17920
  ds_read_b32 v41, v18 offset:18176
  ds_read_b32 v42, v18 offset:18432
  ds_read_b32 v43, v18 offset:18688
  ds_read_b32 v44, v18 offset:18944
  ds_read_b32 v45, v18 offset:19200
  ds_read_b32 v46, v18 offset:19456
  ds_read_b32 v47, v18 offset:19712
  ds_read_b32 v48, v18 offset:19968
  ds_read_b32 v49, v18 offset:20224
  s_waitcnt lgkmcnt(15)
  v_add_f32 v16, v16, v26
  v_add_f32 v17, v17, v27
  v_add_f32 v20, v20, v28
  v_add_f32 v21, v21, v29
  v_add_f32 v22, v22, v30
  v_add_f32 v23, v23, v31
  v_add_f32 v24, v24, v32
  v_add_f32 v25, v25, v33
  s_waitcnt lgkmcnt(0)
  v_add_f32 v34, v34, v42
  v_add_f32 v35, v35, v43
  v_add_f32 v36, v36, v44
  v_add_f32 v37, v37, v45
  v_add_f32 v38, v38, v46
  v_add_f32 v39, v39, v47
  v_add_f32 v40, v40, v48
  v_add_f32 v41, v41, v49
  v_add_f32 v16, v16, v34
  v_add_f32 v17, v17, v35
  v_add_f32 v20, v20, v36
  v_add_f32 v21, v21, v37
  v_add_f32 v22, v22, v38
  v_add_f32 v23, v23, v39
  v_add_f32 v24, v24, v40
  v_add_f32 v25, v25, v41
  v_add_f32 v16, v16, v22
  v_add_f32 v17, v17, v23
  v_add_f32 v20, v20, v24
  v_add_f32 v21, v21, v25
  v_add_f32 v16, v16, v20
  v_add_f32 v17, v17, v21
  v_add_f32 v16, v16, v17
  s_and_b32 s50, s46, 1
  s_mul_i32 s50, s50, 15360
  s_lshr_b32 s51, s46, 1
  s_lshl_b32 s51, s51, 8
  s_add_u32 s50, s50, s51
  s_add_u32 s50, s50, 262144
  buffer_store_dword v16, v18, s[24:27], s50 offen sc0 sc1
L_nomod_9:
  s_waitcnt vmcnt(0)
  s_barrier
  s_waitcnt lgkmcnt(0)
  s_add_u32 s42, s42, 1
  s_cmp_lg_u32 s43, 0
  s_cbranch_scc1 L_noflag_10
  s_lshl_b32 s44, s2, 6
  s_add_u32 s44, s44, 0
  s_mov_b32 exec_lo, 1
  s_mov_b32 exec_hi, 0
  v_mov_b32 v2, s44
  v_mov_b32 v3, s42
  buffer_store_dword v3, v2, s[24:27], 0 offen sc0 sc1
  s_mov_b64 exec, -1
L_noflag_10:
  s_lshl_b32 s44, s43, 5
  s_add_u32 s44, s44, s41
  s_lshl_b32 s44, s44, 6
  v_add_u32 v12, s44, v1
  s_mov_b32 s32, s8
  s_mov_b32 s33, s9
  s_mov_b32 s34, 819200
  s_mov_b32 s35, 0x20000
  v_lshlrev_b32 v12, 7, v12
  buffer_load_dword v15, v12, s[32:35], 0 offen
  s_cmp_lg_u32 s43, 0
  s_cbranch_scc1 L_nowait_11
  s_lshr_b32 s45, s53, 3
  s_add_u32 s45, s45, 128
  v_and_b32 v4, 15, v1
  v_lshlrev_b32 v4, 3, v4
  v_bfe_u32 v2, v1, 4, 1
  v_lshl_add_u32 v4, v2, 2, v4
  v_add_u32 v4, s45, v4
  v_lshlrev_b32 v4, 6, v4
  v_add_u32 v4, 0, v4
  s_mov_b32 s44, 40000
  s_nop 0
L_poll_12:
  buffer_load_dword v8, v4, s[24:27], 0 offen sc0 sc1
  s_waitcnt vmcnt(0)
  v_cmp_ne_u32 vcc, s42, v8
  s_cmp_eq_u64 vcc, 0
  s_nop 3
  s_cbranch_scc1 L_polld_13
  s_sub_u32 s44, s44, 1
  s_cmp_lg_u32 s44, 0
  s_cbranch_scc1 L_poll_12
L_polld_13:
L_nowait_11:
  s_barrier
  s_mul_i32 s44, s53, 81920
  s_mul_i32 s45, s43, 10240
  s_add_u32 s44, s44, s45
  s_add_u32 s48, s44, 27262976
  v_lshlrev_b32 v7, 4, v1
  s_add_u32 s44, s48, 0
  buffer_load_dwordx4 v[96:99], v7, s[24:27], s44 offen offset:0
  s_add_u32 s44, s48, 0
  buffer_load_dwordx4 v[100:103], v7, s[24:27], s44 offen offset:1024
  s_add_u32 s44, s48, 0
  buffer_load_dwordx4 v[104:107], v7, s[24:27], s44 offen offset:2048
  s_add_u32 s44, s48, 0
  buffer_load_dwordx4 v[108:111], v7, s[24:27], s44 offen offset:3072
  s_add_u32 s44, s48, 4096
  buffer_load_dwordx4 v[112:115], v7, s[24:27], s44 offen offset:0
  s_add_u32 s44, s48, 4096
  buffer_load_dwordx4 v[116:119], v7, s[24:27], s44 offen offset:1024
  s_add_u32 s44, s48, 4096
  buffer_load_dwordx4 v[120:123], v7, s[24:27], s44 offen offset:2048
  s_add_u32 s44, s48, 4096
  buffer_load_dwordx4 v[124:127], v7, s[24:27], s44 offen offset:3072
  s_add_u32 s44, s48, 8192
  buffer_load_dwordx4 v[128:131], v7, s[24:27], s44 offen offset:0
  s_add_u32 s44, s48, 8192
  buffer_load_dwordx4 v[132:135], v7, s[24:27], s44 offen offset:1024
  s_cmp_lg_u32 s43, 0
  s_cbranch_scc1 L_nowait_15
  v_add_u32 v4, 0, v1
  v_lshlrev_b32 v4, 6, v4
  v_add_u32 v4, 0, v4
  v_add_u32 v5, 64, v1
  v_lshlrev_b32 v5, 6, v5
  v_add_u32 v5, 0, v5
  v_add_u32 v6, 128, v1
  v_lshlrev_b32 v6, 6, v6
  v_add_u32 v6, 0, v6
  v_add_u32 v7, 192, v1
  v_lshlrev_b32 v7, 6, v7
  v_add_u32 v7, 0, v7
  s_mov_b32 s44, 40000
  s_nop 0
L_poll_16:
  buffer_load_dword v8, v4, s[24:27], 0 offen sc0 sc1
  buffer_load_dword v9, v5, s[24:27], 0 offen sc0 sc1
  buffer_load_dword v10, v6, s[24:27], 0 offen sc0 sc1
  buffer_load_dword v11, v7, s[24:27], 0 offen sc0 sc1
  s_waitcnt vmcnt(0)
  v_cmp_ne_u32 vcc, s42, v8
  v_cmp_ne_u32 s[46:47], s42, v9
  s_nop 0
  s_or_b64 vcc, vcc, s[46:47]
  v_cmp_ne_u32 s[46:47], s42, v10
  s_nop 0
  s_or_b64 vcc, vcc, s[46:47]
  v_cmp_ne_u32 s[46:47], s42, v11
  s_nop 0
  s_or_b64 vcc, vcc, s[46:47]
  s_cmp_eq_u64 vcc, 0
  s_nop 1
  s_cbranch_scc1 L_polld_17
  s_sub_u32 s44, s44, 1
  s_cmp_lg_u32 s44, 0
  s_cbranch_scc1 L_poll_16
L_polld_17:
  s_branch L_wfend_18
L_nowait_15:
L_wfend_18:
  s_barrier
  v_lshlrev_b32 v7, 4, v1
  v_lshlrev_b32 v2, 2, v1
  s_mul_i32 s44, s43, 320
  s_add_u32 s44, s44, 262144
  s_add_u32 s45, s44, 15360
  buffer_load_dword v8, v2, s[24:27], s44 offen
  buffer_load_dword v9, v2, s[24:27], s44 offen offset:2560
  buffer_load_dword v18, v2, s[24:27], s45 offen
  buffer_load_dword v19, v2, s[24:27], s45 offen offset:2560
  s_mov_b32 exec_lo, 65535
  s_mov_b32 exec_hi, 0
  buffer_load_dword v10, v2, s[24:27], s44 offen offset:256
  buffer_load_dword v11, v2, s[24:27], s44 offen offset:2816
  buffer_load_dword v20, v2, s[24:27], s45 offen offset:256
  buffer_load_dword v21, v2, s[24:27], s45 offen offset:2816
  s_mov_b64 exec, -1
  s_mul_i32 s44, s53, 320
  s_add_u32 s44, s44, 267264
  v_lshlrev_b32 v2, 2, v1
  buffer_load_dword v84, v2, s[24:27], s44 offen
  buffer_load_dword v86, v2, s[24:27], s44 offen offset:256
  s_add_u32 s44, s44, 15360
  buffer_load_dword v85, v2, s[24:27], s44 offen
  buffer_load_dword v87, v2, s[24:27], s44 offen offset:256
  s_lshl_b32 s45, s52, 4
  s_lshl_b32 s46, s54, 1
  s_add_u32 s45, s45, s46
  s_mul_i32 s45, s45, 20480
  s_add_u32 s55, s45, 1048576
  s_add_u32 s44, s55, 0
  buffer_load_dwordx4 v[136:139], v7, s[24:27], s44 offen offset:0
  s_add_u32 s44, s55, 20480
  buffer_load_dwordx4 v[140:143], v7, s[24:27], s44 offen offset:0
  s_add_u32 s44, s55, 0
  buffer_load_dwordx4 v[144:147], v7, s[24:27], s44 offen offset:1024
  s_add_u32 s44, s55, 20480
  buffer_load_dwordx4 v[148:151], v7, s[24:27], s44 offen offset:1024
  s_add_u32 s44, s55, 0
  buffer_load_dwordx4 v[152:155], v7, s[24:27], s44 offen offset:2048
  s_add_u32 s44, s55, 20480
  buffer_load_dwordx4 v[156:159], v7, s[24:27], s44 offen offset:2048
  s_add_u32 s44, s55, 0
  buffer_load_dwordx4 v[160:163], v7, s[24:27], s44 offen offset:3072
  s_add_u32 s44, s55, 20480
  buffer_load_dwordx4 v[164:167], v7, s[24:27], s44 offen offset:3072
  s_add_u32 s44, s55, 4096
  buffer_load_dwordx4 v[168:171], v7, s[24:27], s44 offen offset:0
  s_add_u32 s44, s55, 24576
  buffer_load_dwordx4 v[172:175], v7, s[24:27], s44 offen offset:0
  s_mul_i32 s47, s43, 640
  s_add_u32 s47, s47, 147456
  v_lshl_add_u32 v12, v1, 3, s47
  s_waitcnt vmcnt(18)
  v_add_f32 v8, v8, v18
  v_add_f32 v9, v9, v19
  v_cvt_pk_bf16_f32 v8, v8, v9
  v_and_b32 v9, 0xffff0000, v8
  v_lshlrev_b32 v15, 16, v8
  v_add_f32 v9, 1.0, v9
  v_cvt_pk_bf16_f32 v9, v9, v9
  v_and_b32 v14, 0xffff0000, v9
  ds_write_b64 v12, v[14:15]
  s_waitcnt vmcnt(14)
  v_add_f32 v10, v10, v20
  v_add_f32 v11, v11, v21
  v_cvt_pk_bf16_f32 v10, v10, v11
  v_and_b32 v11, 0xffff0000, v10
  v_lshlrev_b32 v15, 16, v10
  v_add_f32 v11, 1.0, v11
  v_cvt_pk_bf16_f32 v11, v11, v11
  v_and_b32 v14, 0xffff0000, v11
  s_mov_b32 exec_lo, 65535
  s_mov_b32 exec_hi, 0
  ds_write_b64 v12, v[14:15] offset:512
  s_mov_b64 exec, -1
  v_lshrrev_b32 v3, 3, v1
  v_and_b32 v2, 7, v1
  v_lshl_add_u32 v12, v3, 3, s47
  s_mul_i32 s45, s43, 10240
  v_lshlrev_b32 v13, 7, v3
  v_add_u32 v13, s45, v13
  v_and_b32 v4, 2, v3
  v_xor_b32 v4, v4, v2
  v_lshl_add_u32 v16, v4, 4, v13
  v_xor_b32 v17, 64, v16
  v_mov_b32 v44, 0
  v_mov_b32 v45, 0
  v_mov_b32 v46, 0
  v_mov_b32 v47, 0
  v_mov_b32 v48, 0
  v_mov_b32 v49, 0
  v_mov_b32 v50, 0
  v_mov_b32 v51, 0
  s_waitcnt lgkmcnt(0)
  ds_read_b64 v[24:25], v12 offset:0
  ds_read_b64 v[26:27], v12 offset:64
  ds_read_b64 v[28:29], v12 offset:128
  ds_read_b64 v[30:31], v12 offset:192
  ds_read_b64 v[32:33], v12 offset:256
  ds_read_b64 v[34:35], v12 offset:320
  ds_read_b64 v[36:37], v12 offset:384
  ds_read_b64 v[38:39], v12 offset:448
  ds_read_b64 v[40:41], v12 offset:512
  ds_read_b64 v[42:43], v12 offset:576
  v_lshlrev_b32 v52, 16, v96
  v_and_b32 v53, 0xffff0000, v96
  v_lshlrev_b32 v54, 16, v97
  v_and_b32 v55, 0xffff0000, v97
  v_lshlrev_b32 v56, 16, v98
  v_and_b32 v57, 0xffff0000, v98
  v_lshlrev_b32 v58, 16, v99
  v_and_b32 v59, 0xffff0000, v99
  s_waitcnt lgkmcnt(0)
  s_add_u32 s44, s55, 4096
  buffer_load_dwordx4 v[176:179], v7, s[24:27], s44 offen offset:1024
  v_fmac_f32 v44, v25, v52
  v_fmac_f32 v45, v25, v53
  v_fmac_f32 v46, v25, v54
  v_fmac_f32 v47, v25, v55
  v_fmac_f32 v48, v25, v56
  v_fmac_f32 v49, v25, v57
  v_fmac_f32 v50, v25, v58
  v_fmac_f32 v51, v25, v59
  v_mul_f32 v52, v24, v52
  v_mul_f32 v53, v24, v53
  v_mul_f32 v54, v24, v54
  v_mul_f32 v55, v24, v55
  v_mul_f32 v56, v24, v56
  v_mul_f32 v57, v24, v57
  v_mul_f32 v58, v24, v58
  v_mul_f32 v59, v24, v59
  s_add_u32 s44, s55, 24576
  buffer_load_dwordx4 v[180:183], v7, s[24:27], s44 offen offset:1024
  v_cvt_pk_bf16_f32 v60, v52, v53
  v_cvt_pk_bf16_f32 v61, v54, v55
  v_cvt_pk_bf16_f32 v62, v56, v57
  v_cvt_pk_bf16_f32 v63, v58, v59
  ds_write_b128 v16, v[60:63] offset:0
  v_lshlrev_b32 v52, 16, v100
  v_and_b32 v53, 0xffff0000, v100
  v_lshlrev_b32 v54, 16, v101
  v_and_b32 v55, 0xffff0000, v101
  v_lshlrev_b32 v56, 16, v102
  v_and_b32 v57, 0xffff0000, v102
  v_lshlrev_b32 v58, 16, v103
  v_and_b32 v59, 0xffff0000, v103
  s_add_u32 s44, s55, 4096
  buffer_load_dwordx4 v[184:187], v7, s[24:27], s44 offen offset:2048
  v_fmac_f32 v44, v27, v52
  v_fmac_f32 v45, v27, v53
  v_fmac_f32 v46, v27, v54
  v_fmac_f32 v47, v27, v55
  v_fmac_f32 v48, v27, v56
  v_fmac_f32 v49, v27, v57
  v_fmac_f32 v50, v27, v58
  v_fmac_f32 v51, v27, v59
  v_mul_f32 v52, v26, v52
  v_mul_f32 v53, v26, v53
  v_mul_f32 v54, v26, v54
  v_mul_f32 v55, v26, v55
  v_mul_f32 v56, v26, v56
  v_mul_f32 v57, v26, v57
  v_mul_f32 v58, v26, v58
  v_mul_f32 v59, v26, v59
  s_add_u32 s44, s55, 24576
  buffer_load_dwordx4 v[188:191], v7, s[24:27], s44 offen offset:2048
  v_cvt_pk_bf16_f32 v60, v52, v53
  v_cvt_pk_bf16_f32 v61, v54, v55
  v_cvt_pk_bf16_f32 v62, v56, v57
  v_cvt_pk_bf16_f32 v63, v58, v59
  ds_write_b128 v17, v[60:63] offset:1024
  v_lshlrev_b32 v52, 16, v104
  v_and_b32 v53, 0xffff0000, v104
  v_lshlrev_b32 v54, 16, v105
  v_and_b32 v55, 0xffff0000, v105
  v_lshlrev_b32 v56, 16, v106
  v_and_b32 v57, 0xffff0000, v106
  v_lshlrev_b32 v58, 16, v107
  v_and_b32 v59, 0xffff0000, v107
  s_add_u32 s44, s55, 4096
  buffer_load_dwordx4 v[192:195], v7, s[24:27], s44 offen offset:3072
  v_fmac_f32 v44, v29, v52
  v_fmac_f32 v45, v29, v53
  v_fmac_f32 v46, v29, v54
  v_fmac_f32 v47, v29, v55
  v_fmac_f32 v48, v29, v56
  v_fmac_f32 v49, v29, v57
  v_fmac_f32 v50, v29, v58
  v_fmac_f32 v51, v29, v59
  v_mul_f32 v52, v28, v52
  v_mul_f32 v53, v28, v53
  v_mul_f32 v54, v28, v54
  v_mul_f32 v55, v28, v55
  v_mul_f32 v56, v28, v56
  v_mul_f32 v57, v28, v57
  v_mul_f32 v58, v28, v58
  v_mul_f32 v59, v28, v59
  s_add_u32 s44, s55, 24576
  buffer_load_dwordx4 v[196:199], v7, s[24:27], s44 offen offset:3072
  v_cvt_pk_bf16_f32 v60, v52, v53
  v_cvt_pk_bf16_f32 v61, v54, v55
  v_cvt_pk_bf16_f32 v62, v56, v57
  v_cvt_pk_bf16_f32 v63, v58, v59
  ds_write_b128 v16, v[60:63] offset:2048
  v_lshlrev_b32 v52, 16, v108
  v_and_b32 v53, 0xffff0000, v108
  v_lshlrev_b32 v54, 16, v109
  v_and_b32 v55, 0xffff0000, v109
  v_lshlrev_b32 v56, 16, v110
  v_and_b32 v57, 0xffff0000, v110
  v_lshlrev_b32 v58, 16, v111
  v_and_b32 v59, 0xffff0000, v111
  s_add_u32 s44, s55, 8192
  buffer_load_dwordx4 v[200:203], v7, s[24:27], s44 offen offset:0
  v_fmac_f32 v44, v31, v52
  v_fmac_f32 v45, v31, v53
  v_fmac_f32 v46, v31, v54
  v_fmac_f32 v47, v31, v55
  v_fmac_f32 v48, v31, v56
  v_fmac_f32 v49, v31, v57
  v_fmac_f32 v50, v31, v58
  v_fmac_f32 v51, v31, v59
  v_mul_f32 v52, v30, v52
  v_mul_f32 v53, v30, v53
  v_mul_f32 v54, v30, v54
  v_mul_f32 v55, v30, v55
  v_mul_f32 v56, v30, v56
  v_mul_f32 v57, v30, v57
  v_mul_f32 v58, v30, v58
  v_mul_f32 v59, v30, v59
  s_add_u32 s44, s55, 28672
  buffer_load_dwordx4 v[204:207], v7, s[24:27], s44 offen offset:0
  v_cvt_pk_bf16_f32 v60, v52, v53
  v_cvt_pk_bf16_f32 v61, v54, v55
  v_cvt_pk_bf16_f32 v62, v56, v57
  v_cvt_pk_bf16_f32 v63, v58, v59
  ds_write_b128 v17, v[60:63] offset:3072
  v_lshlrev_b32 v52, 16, v112
  v_and_b32 v53, 0xffff0000, v112
  v_lshlrev_b32 v54, 16, v113
  v_and_b32 v55, 0xffff0000, v113
  v_lshlrev_b32 v56, 16, v114
  v_and_b32 v57, 0xffff0000, v114
  v_lshlrev_b32 v58, 16, v115
  v_and_b32 v59, 0xffff0000, v115
  s_add_u32 s44, s55, 8192
  buffer_load_dwordx4 v[208:211], v7, s[24:27], s44 offen offset:1024
  v_fmac_f32 v44, v33, v52
  v_fmac_f32 v45, v33, v53
  v_fmac_f32 v46, v33, v54
  v_fmac_f32 v47, v33, v55
  v_fmac_f32 v48, v33, v56
  v_fmac_f32 v49, v33, v57
  v_fmac_f32 v50, v33, v58
  v_fmac_f32 v51, v33, v59
  v_mul_f32 v52, v32, v52
  v_mul_f32 v53, v32, v53
  v_mul_f32 v54, v32, v54
  v_mul_f32 v55, v32, v55
  v_mul_f32 v56, v32, v56
  v_mul_f32 v57, v32, v57
  v_mul_f32 v58, v32, v58
  v_mul_f32 v59, v32, v59
  s_add_u32 s44, s55, 28672
  buffer_load_dwordx4 v[212:215], v7, s[24:27], s44 offen offset:1024
  v_cvt_pk_bf16_f32 v60, v52, v53
  v_cvt_pk_bf16_f32 v61, v54, v55
  v_cvt_pk_bf16_f32 v62, v56, v57
  v_cvt_pk_bf16_f32 v63, v58, v59
  ds_write_b128 v16, v[60:63] offset:4096
  v_lshlrev_b32 v52, 16, v116
  v_and_b32 v53, 0xffff0000, v116
  v_lshlrev_b32 v54, 16, v117
  v_and_b32 v55, 0xffff0000, v117
  v_lshlrev_b32 v56, 16, v118
  v_and_b32 v57, 0xffff0000, v118
  v_lshlrev_b32 v58, 16, v119
  v_and_b32 v59, 0xffff0000, v119
  s_add_u32 s44, s55, 8192
  buffer_load_dwordx4 v[216:219], v7, s[24:27], s44 offen offset:2048
  v_fmac_f32 v44, v35, v52
  v_fmac_f32 v45, v35, v53
  v_fmac_f32 v46, v35, v54
  v_fmac_f32 v47, v35, v55
  v_fmac_f32 v48, v35, v56
  v_fmac_f32 v49, v35, v57
  v_fmac_f32 v50, v35, v58
  v_fmac_f32 v51, v35, v59
  v_mul_f32 v52, v34, v52
  v_mul_f32 v53, v34, v53
  v_mul_f32 v54, v34, v54
  v_mul_f32 v55, v34, v55
  v_mul_f32 v56, v34, v56
  v_mul_f32 v57, v34, v57
  v_mul_f32 v58, v34, v58
  v_mul_f32 v59, v34, v59
  s_add_u32 s44, s55, 28672
  buffer_load_dwordx4 v[220:223], v7, s[24:27], s44 offen offset:2048
  v_cvt_pk_bf16_f32 v60, v52, v53
  v_cvt_pk_bf16_f32 v61, v54, v55
  v_cvt_pk_bf16_f32 v62, v56, v57
  v_cvt_pk_bf16_f32 v63, v58, v59
  ds_write_b128 v17, v[60:63] offset:5120
  v_lshlrev_b32 v52, 16, v120
  v_and_b32 v53, 0xffff0000, v120
  v_lshlrev_b32 v54, 16, v121
  v_and_b32 v55, 0xffff0000, v121
  v_lshlrev_b32 v56, 16, v122
  v_and_b32 v57, 0xffff0000, v122
  v_lshlrev_b32 v58, 16, v123
  v_and_b32 v59, 0xffff0000, v123
  s_add_u32 s44, s55, 8192
  buffer_load_dwordx4 v[224:227], v7, s[24:27], s44 offen offset:3072
  v_fmac_f32 v44, v37, v52
  v_fmac_f32 v45, v37, v53
  v_fmac_f32 v46, v37, v54
  v_fmac_f32 v47, v37, v55
  v_fmac_f32 v48, v37, v56
  v_fmac_f32 v49, v37, v57
  v_fmac_f32 v50, v37, v58
  v_fmac_f32 v51, v37, v59
  v_mul_f32 v52, v36, v52
  v_mul_f32 v53, v36, v53
  v_mul_f32 v54, v36, v54
  v_mul_f32 v55, v36, v55
  v_mul_f32 v56, v36, v56
  v_mul_f32 v57, v36, v57
  v_mul_f32 v58, v36, v58
  v_mul_f32 v59, v36, v59
  s_add_u32 s44, s55, 28672
  buffer_load_dwordx4 v[228:231], v7, s[24:27], s44 offen offset:3072
  v_cvt_pk_bf16_f32 v60, v52, v53
  v_cvt_pk_bf16_f32 v61, v54, v55
  v_cvt_pk_bf16_f32 v62, v56, v57
  v_cvt_pk_bf16_f32 v63, v58, v59
  ds_write_b128 v16, v[60:63] offset:6144
  v_lshlrev_b32 v52, 16, v124
  v_and_b32 v53, 0xffff0000, v124
  v_lshlrev_b32 v54, 16, v125
  v_and_b32 v55, 0xffff0000, v125
  v_lshlrev_b32 v56, 16, v126
  v_and_b32 v57, 0xffff0000, v126
  v_lshlrev_b32 v58, 16, v127
  v_and_b32 v59, 0xffff0000, v127
  s_add_u32 s44, s55, 12288
  buffer_load_dwordx4 v[232:235], v7, s[24:27], s44 offen offset:0
  v_fmac_f32 v44, v39, v52
  v_fmac_f32 v45, v39, v53
  v_fmac_f32 v46, v39, v54
  v_fmac_f32 v47, v39, v55
  v_fmac_f32 v48, v39, v56
  v_fmac_f32 v49, v39, v57
  v_fmac_f32 v50, v39, v58
  v_fmac_f32 v51, v39, v59
  v_mul_f32 v52, v38, v52
  v_mul_f32 v53, v38, v53
  v_mul_f32 v54, v38, v54
  v_mul_f32 v55, v38, v55
  v_mul_f32 v56, v38, v56
  v_mul_f32 v57, v38, v57
  v_mul_f32 v58, v38, v58
  v_mul_f32 v59, v38, v59
  s_add_u32 s44, s55, 32768
  buffer_load_dwordx4 v[236:239], v7, s[24:27], s44 offen offset:0
  v_cvt_pk_bf16_f32 v60, v52, v53
  v_cvt_pk_bf16_f32 v61, v54, v55
  v_cvt_pk_bf16_f32 v62, v56, v57
  v_cvt_pk_bf16_f32 v63, v58, v59
  ds_write_b128 v17, v[60:63] offset:7168
  v_lshlrev_b32 v52, 16, v128
  v_and_b32 v53, 0xffff0000, v128
  v_lshlrev_b32 v54, 16, v129
  v_and_b32 v55, 0xffff0000, v129
  v_lshlrev_b32 v56, 16, v130
  v_and_b32 v57, 0xffff0000, v130
  v_lshlrev_b32 v58, 16, v131
  v_and_b32 v59, 0xffff0000, v131
  s_add_u32 s44, s55, 12288
  buffer_load_dwordx4 v[240:243], v7, s[24:27], s44 offen offset:1024
  v_fmac_f32 v44, v41, v52
  v_fmac_f32 v45, v41, v53
  v_fmac_f32 v46, v41, v54
  v_fmac_f32 v47, v41, v55
  v_fmac_f32 v48, v41, v56
  v_fmac_f32 v49, v41, v57
  v_fmac_f32 v50, v41, v58
  v_fmac_f32 v51, v41, v59
  v_mul_f32 v52, v40, v52
  v_mul_f32 v53, v40, v53
  v_mul_f32 v54, v40, v54
  v_mul_f32 v55, v40, v55
  v_mul_f32 v56, v40, v56
  v_mul_f32 v57, v40, v57
  v_mul_f32 v58, v40, v58
  v_mul_f32 v59, v40, v59
  s_add_u32 s44, s55, 32768
  buffer_load_dwordx4 v[244:247], v7, s[24:27], s44 offen offset:1024
  v_cvt_pk_bf16_f32 v60, v52, v53
  v_cvt_pk_bf16_f32 v61, v54, v55
  v_cvt_pk_bf16_f32 v62, v56, v57
  v_cvt_pk_bf16_f32 v63, v58, v59
  ds_write_b128 v16, v[60:63] offset:8192
  v_lshlrev_b32 v52, 16, v132
  v_and_b32 v53, 0xffff0000, v132
  v_lshlrev_b32 v54, 16, v133
  v_and_b32 v55, 0xffff0000, v133
  v_lshlrev_b32 v56, 16, v134
  v_and_b32 v57, 0xffff0000, v134
  v_lshlrev_b32 v58, 16, v135
  v_and_b32 v59, 0xffff0000, v135
  s_add_u32 s44, s55, 12288
  buffer_load_dwordx4 v[248:251], v7, s[24:27], s44 offen offset:2048
  v_fmac_f32 v44, v43, v52
  v_fmac_f32 v45, v43, v53
  v_fmac_f32 v46, v43, v54
  v_fmac_f32 v47, v43, v55
  v_fmac_f32 v48, v43, v56
  v_fmac_f32 v49, v43, v57
  v_fmac_f32 v50, v43, v58
  v_fmac_f32 v51, v43, v59
  v_mul_f32 v52, v42, v52
  v_mul_f32 v53, v42, v53
  v_mul_f32 v54, v42, v54
  v_mul_f32 v55, v42, v55
  v_mul_f32 v56, v42, v56
  v_mul_f32 v57, v42, v57
  v_mul_f32 v58, v42, v58
  v_mul_f32 v59, v42, v59
  s_add_u32 s44, s55, 32768
  buffer_load_dwordx4 v[252:255], v7, s[24:27], s44 offen offset:2048
  v_cvt_pk_bf16_f32 v60, v52, v53
  v_cvt_pk_bf16_f32 v61, v54, v55
  v_cvt_pk_bf16_f32 v62, v56, v57
  v_cvt_pk_bf16_f32 v63, v58, v59
  ds_write_b128 v17, v[60:63] offset:9216
  v_add_f32_dpp v44, v44, v44 row_shr:8 row_mask:0xf bank_mask:0xf bound_ctrl:0
  v_add_f32_dpp v45, v45, v45 row_shr:8 row_mask:0xf bank_mask:0xf bound_ctrl:0
  v_add_f32_dpp v46, v46, v46 row_shr:8 row_mask:0xf bank_mask:0xf bound_ctrl:0
  v_add_f32_dpp v47, v47, v47 row_shr:8 row_mask:0xf bank_mask:0xf bound_ctrl:0
  v_add_f32_dpp v48, v48, v48 row_shr:8 row_mask:0xf bank_mask:0xf bound_ctrl:0
  v_add_f32_dpp v49, v49, v49 row_shr:8 row_mask:0xf bank_mask:0xf bound_ctrl:0
  v_add_f32_dpp v50, v50, v50 row_shr:8 row_mask:0xf bank_mask:0xf bound_ctrl:0
  v_add_f32_dpp v51, v51, v51 row_shr:8 row_mask:0xf bank_mask:0xf bound_ctrl:0
  s_lshl_b32 s45, s43, 10
  s_add_u32 s45, s45, 152576
  v_lshrrev_b32 v4, 4, v1
  v_lshlrev_b32 v4, 8, v4
  v_lshl_add_u32 v4, v2, 5, v4
  v_add_u32 v4, s45, v4
  s_mov_b32 exec_lo, 0xff00ff00
  s_mov_b32 exec_hi, 0xff00ff00
  ds_write_b128 v4, v[44:47]
  ds_write_b128 v4, v[48:51] offset:16
  s_mov_b64 exec, -1
  s_waitcnt lgkmcnt(0)
  s_barrier
  s_cmp_lg_u32 s43, 0
  s_cbranch_scc1 L_c2_19
  v_lshlrev_b32 v4, 2, v1
  v_add_u32 v4, 152576, v4
  ds_read_b32 v20, v4 offset:0
  ds_read_b32 v21, v4 offset:256
  ds_read_b32 v22, v4 offset:512
  ds_read_b32 v23, v4 offset:768
  ds_read_b32 v24, v4 offset:1024
  ds_read_b32 v25, v4 offset:1280
  ds_read_b32 v26, v4 offset:1536
  ds_read_b32 v27, v4 offset:1792
  s_waitcnt lgkmcnt(0)
  v_add_f32 v19, v20, v21
  v_add_f32 v19, v19, v22
  v_add_f32 v19, v19, v23
  v_add_f32 v19, v19, v24
  v_add_f32 v19, v19, v25
  v_add_f32 v19, v19, v26
  v_add_f32 v19, v19, v27
  ds_read_b32 v20, v4 offset:2048
  ds_read_b32 v21, v4 offset:2304
  ds_read_b32 v22, v4 offset:2560
  ds_read_b32 v23, v4 offset:2816
  ds_read_b32 v24, v4 offset:3072
  ds_read_b32 v25, v4 offset:3328
  ds_read_b32 v26, v4 offset:3584
  ds_read_b32 v27, v4 offset:3840
  s_waitcnt lgkmcnt(0)
  v_add_f32 v19, v19, v20
  v_add_f32 v19, v19, v21
  v_add_f32 v19, v19, v22
  v_add_f32 v19, v19, v23
  v_add_f32 v19, v19, v24
  v_add_f32 v19, v19, v25
  v_add_f32 v19, v19, v26
  v_add_f32 v19, v19, v27
  ds_read_b32 v20, v4 offset:4096
  ds_read_b32 v21, v4 offset:4352
  ds_read_b32 v22, v4 offset:4608
  ds_read_b32 v23, v4 offset:4864
  ds_read_b32 v24, v4 offset:5120
  ds_read_b32 v25, v4 offset:5376
  ds_read_b32 v26, v4 offset:5632
  ds_read_b32 v27, v4 offset:5888
  s_waitcnt lgkmcnt(0)
  v_add_f32 v19, v19, v20
  v_add_f32 v19, v19, v21
  v_add_f32 v19, v19, v22
  v_add_f32 v19, v19, v23
  v_add_f32 v19, v19, v24
  v_add_f32 v19, v19, v25
  v_add_f32 v19, v19, v26
  v_add_f32 v19, v19, v27
  ds_read_b32 v20, v4 offset:6144
  ds_read_b32 v21, v4 offset:6400
  ds_read_b32 v22, v4 offset:6656
  ds_read_b32 v23, v4 offset:6912
  ds_read_b32 v24, v4 offset:7168
  ds_read_b32 v25, v4 offset:7424
  ds_read_b32 v26, v4 offset:7680
  ds_read_b32 v27, v4 offset:7936
  s_waitcnt lgkmcnt(0)
  v_add_f32 v19, v19, v20
  v_add_f32 v19, v19, v21
  v_add_f32 v19, v19, v22
  v_add_f32 v19, v19, v23
  v_add_f32 v19, v19, v24
  v_add_f32 v19, v19, v25
  v_add_f32 v19, v19, v26
  v_add_f32 v19, v19, v27
  ds_write_b32 v4, v19 offset:8192
  s_nop 0
L_c2_19:
  v_lshrrev_b32 v2, 4, v1
  v_bfe_u32 v3, v1, 2, 2
  v_and_b32 v4, 3, v1
  v_lshl_add_u32 v5, v2, 3, v3
  v_lshlrev_b32 v5, 7, v5
  v_lshl_add_u32 v5, v4, 3, v5
  v_lshrrev_b32 v6, 1, v3
  v_and_b32 v8, 1, v2
  v_lshl_add_u32 v6, v8, 1, v6
  v_xor_b32 v8, 0, v6
  v_lshl_add_u32 v9, v8, 5, v5
  v_xor_b32 v8, 1, v6
  v_lshl_add_u32 v10, v8, 5, v5
  v_xor_b32 v8, 2, v6
  v_lshl_add_u32 v11, v8, 5, v5
  v_xor_b32 v8, 3, v6
  v_lshl_add_u32 v12, v8, 5, v5
  v_mov_b32 v16, 0
  v_mov_b32 v17, 0
  v_mov_b32 v18, 0
  v_mov_b32 v19, 0
  v_mov_b32 v20, 0
  v_mov_b32 v21, 0
  v_mov_b32 v22, 0
  v_mov_b32 v23, 0
  v_mov_b32 v24, 0
  v_mov_b32 v25, 0
  v_mov_b32 v26, 0
  v_mov_b32 v27, 0
  v_mov_b32 v28, 0
  v_mov_b32 v29, 0
  v_mov_b32 v30, 0
  v_mov_b32 v31, 0
  v_mov_b32 v32, 0
  v_mov_b32 v33, 0
  v_mov_b32 v34, 0
  v_mov_b32 v35, 0
  v_mov_b32 v36, 0
  v_mov_b32 v37, 0
  v_mov_b32 v38, 0
  v_mov_b32 v39, 0
  v_mov_b32 v40, 0
  v_mov_b32 v41, 0
  v_mov_b32 v42, 0
  v_mov_b32 v43, 0
  v_mov_b32 v44, 0
  v_mov_b32 v45, 0
  v_mov_b32 v46, 0
  v_mov_b32 v47, 0
  v_add_u32 v80, 40960, v9
  v_add_u32 v81, 40960, v10
  v_add_u32 v82, 40960, v11
  v_add_u32 v83, 40960, v12
  ds_read_b64_tr_b16 v[48:49], v9 offset:0
  ds_read_b64_tr_b16 v[50:51], v9 offset:512
  ds_read_b64_tr_b16 v[52:53], v10 offset:0
  ds_read_b64_tr_b16 v[54:55], v10 offset:512
  ds_read_b64_tr_b16 v[56:57], v11 offset:0
  ds_read_b64_tr_b16 v[58:59], v11 offset:512
  ds_read_b64_tr_b16 v[60:61], v12 offset:0
  ds_read_b64_tr_b16 v[62:63], v12 offset:512
  s_waitcnt lgkmcnt(0)
  s_waitcnt vmcnt(28)
  v_mfma_f32_16x16x32_bf16 v[16:19], v[48:51], v[136:139], v[16:19]
  ds_read_b64_tr_b16 v[64:65], v9 offset:4096
  ds_read_b64_tr_b16 v[66:67], v9 offset:4608
  v_mfma_f32_16x16x32_bf16 v[32:35], v[48:51], v[140:143], v[32:35]
  ds_read_b64_tr_b16 v[68:69], v10 offset:4096
  ds_read_b64_tr_b16 v[70:71], v10 offset:4608
  v_mfma_f32_16x16x32_bf16 v[20:23], v[52:55], v[136:139], v[20:23]
  ds_read_b64_tr_b16 v[72:73], v11 offset:4096
  ds_read_b64_tr_b16 v[74:75], v11 offset:4608
  v_mfma_f32_16x16x32_bf16 v[36:39], v[52:55], v[140:143], v[36:39]
  ds_read_b64_tr_b16 v[76:77], v12 offset:4096
  ds_read_b64_tr_b16 v[78:79], v12 offset:4608
  v_mfma_f32_16x16x32_bf16 v[24:27], v[56:59], v[136:139], v[24:27]
  s_add_u32 s44, s55, 12288
  buffer_load_dwordx4 v[96:99], v7, s[24:27], s44 offen offset:3072
  v_mfma_f32_16x16x32_bf16 v[40:43], v[56:59], v[140:143], v[40:43]
  s_add_u32 s44, s55, 32768
  buffer_load_dwordx4 v[100:103], v7, s[24:27], s44 offen offset:3072
  v_mfma_f32_16x16x32_bf16 v[28:31], v[60:63], v[136:139], v[28:31]
  v_mfma_f32_16x16x32_bf16 v[44:47], v[60:63], v[140:143], v[44:47]
  s_waitcnt lgkmcnt(0)
  s_waitcnt vmcnt(28)
  v_mfma_f32_16x16x32_bf16 v[16:19], v[64:67], v[144:147], v[16:19]
  ds_read_b64_tr_b16 v[48:49], v9 offset:8192
  ds_read_b64_tr_b16 v[50:51], v9 offset:8704
  v_mfma_f32_16x16x32_bf16 v[32:35], v[64:67], v[148:151], v[32:35]
  ds_read_b64_tr_b16 v[52:53], v10 offset:8192
  ds_read_b64_tr_b16 v[54:55], v10 offset:8704
  v_mfma_f32_16x16x32_bf16 v[20:23], v[68:71], v[144:147], v[20:23]
  ds_read_b64_tr_b16 v[56:57], v11 offset:8192
  ds_read_b64_tr_b16 v[58:59], v11 offset:8704
  v_mfma_f32_16x16x32_bf16 v[36:39], v[68:71], v[148:151], v[36:39]
  ds_read_b64_tr_b16 v[60:61], v12 offset:8192
  ds_read_b64_tr_b16 v[62:63], v12 offset:8704
  v_mfma_f32_16x16x32_bf16 v[24:27], v[72:75], v[144:147], v[24:27]
  s_add_u32 s44, s55, 16384
  buffer_load_dwordx4 v[104:107], v7, s[24:27], s44 offen offset:0
  v_mfma_f32_16x16x32_bf16 v[40:43], v[72:75], v[148:151], v[40:43]
  s_add_u32 s44, s55, 36864
  buffer_load_dwordx4 v[108:111], v7, s[24:27], s44 offen offset:0
  v_mfma_f32_16x16x32_bf16 v[28:31], v[76:79], v[144:147], v[28:31]
  v_mfma_f32_16x16x32_bf16 v[44:47], v[76:79], v[148:151], v[44:47]
  s_waitcnt lgkmcnt(0)
  s_waitcnt vmcnt(28)
  v_mfma_f32_16x16x32_bf16 v[16:19], v[48:51], v[152:155], v[16:19]
  ds_read_b64_tr_b16 v[64:65], v9 offset:12288
  ds_read_b64_tr_b16 v[66:67], v9 offset:12800
  v_mfma_f32_16x16x32_bf16 v[32:35], v[48:51], v[156:159], v[32:35]
  ds_read_b64_tr_b16 v[68:69], v10 offset:12288
  ds_read_b64_tr_b16 v[70:71], v10 offset:12800
  v_mfma_f32_16x16x32_bf16 v[20:23], v[52:55], v[152:155], v[20:23]
  ds_read_b64_tr_b16 v[72:73], v11 offset:12288
  ds_read_b64_tr_b16 v[74:75], v11 offset:12800
  v_mfma_f32_16x16x32_bf16 v[36:39], v[52:55], v[156:159], v[36:39]
  ds_read_b64_tr_b16 v[76:77], v12 offset:12288
  ds_read_b64_tr_b16 v[78:79], v12 offset:12800
  v_mfma_f32_16x16x32_bf16 v[24:27], v[56:59], v[152:155], v[24:27]
  s_add_u32 s44, s55, 16384
  buffer_load_dwordx4 v[112:115], v7, s[24:27], s44 offen offset:1024
  v_mfma_f32_16x16x32_bf16 v[40:43], v[56:59], v[156:159], v[40:43]
  s_add_u32 s44, s55, 36864
  buffer_load_dwordx4 v[116:119], v7, s[24:27], s44 offen offset:1024
  v_mfma_f32_16x16x32_bf16 v[28:31], v[60:63], v[152:155], v[28:31]
  v_mfma_f32_16x16x32_bf16 v[44:47], v[60:63], v[156:159], v[44:47]
  s_waitcnt lgkmcnt(0)
  s_waitcnt vmcnt(28)
  v_mfma_f32_16x16x32_bf16 v[16:19], v[64:67], v[160:163], v[16:19]
  ds_read_b64_tr_b16 v[48:49], v9 offset:16384
  ds_read_b64_tr_b16 v[50:51], v9 offset:16896
  v_mfma_f32_16x16x32_bf16 v[32:35], v[64:67], v[164:167], v[32:35]
  ds_read_b64_tr_b16 v[52:53], v10 offset:16384
  ds_read_b64_tr_b16 v[54:55], v10 offset:16896
  v_mfma_f32_16x16x32_bf16 v[20:23], v[68:71], v[160:163], v[20:23]
  ds_read_b64_tr_b16 v[56:57], v11 offset:16384
  ds_read_b64_tr_b16 v[58:59], v11 offset:16896
  v_mfma_f32_16x16x32_bf16 v[36:39], v[68:71], v[164:167], v[36:39]
  ds_read_b64_tr_b16 v[60:61], v12 offset:16384
  ds_read_b64_tr_b16 v[62:63], v12 offset:16896
  v_mfma_f32_16x16x32_bf16 v[24:27], v[72:75], v[160:163], v[24:27]
  s_add_u32 s44, s55, 16384
  buffer_load_dwordx4 v[120:123], v7, s[24:27], s44 offen offset:2048
  v_mfma_f32_16x16x32_bf16 v[40:43], v[72:75], v[164:167], v[40:43]
  s_add_u32 s44, s55, 36864
  buffer_load_dwordx4 v[124:127], v7, s[24:27], s44 offen offset:2048
  v_mfma_f32_16x16x32_bf16 v[28:31], v[76:79], v[160:163], v[28:31]
  v_mfma_f32_16x16x32_bf16 v[44:47], v[76:79], v[164:167], v[44:47]
  s_waitcnt lgkmcnt(0)
  s_waitcnt vmcnt(28)
  v_mfma_f32_16x16x32_bf16 v[16:19], v[48:51], v[168:171], v[16:19]
  ds_read_b64_tr_b16 v[64:65], v9 offset:20480
  ds_read_b64_tr_b16 v[66:67], v9 offset:20992
  v_mfma_f32_16x16x32_bf16 v[32:35], v[48:51], v[172:175], v[32:35]
  ds_read_b64_tr_b16 v[68:69], v10 offset:20480
  ds_read_b64_tr_b16 v[70:71], v10 offset:20992
  v_mfma_f32_16x16x32_bf16 v[20:23], v[52:55], v[168:171], v[20:23]
  ds_read_b64_tr_b16 v[72:73], v11 offset:20480
  ds_read_b64_tr_b16 v[74:75], v11 offset:20992
  v_mfma_f32_16x16x32_bf16 v[36:39], v[52:55], v[172:175], v[36:39]
  ds_read_b64_tr_b16 v[76:77], v12 offset:20480
  ds_read_b64_tr_b16 v[78:79], v12 offset:20992
  v_mfma_f32_16x16x32_bf16 v[24:27], v[56:59], v[168:171], v[24:27]
  s_add_u32 s44, s55, 16384
  buffer_load_dwordx4 v[128:131], v7, s[24:27], s44 offen offset:3072
  v_mfma_f32_16x16x32_bf16 v[40:43], v[56:59], v[172:175], v[40:43]
  s_add_u32 s44, s55, 36864
  buffer_load_dwordx4 v[132:135], v7, s[24:27], s44 offen offset:3072
  v_mfma_f32_16x16x32_bf16 v[28:31], v[60:63], v[168:171], v[28:31]
  v_mfma_f32_16x16x32_bf16 v[44:47], v[60:63], v[172:175], v[44:47]
  s_waitcnt lgkmcnt(0)
  s_waitcnt vmcnt(28)
  v_mfma_f32_16x16x32_bf16 v[16:19], v[64:67], v[176:179], v[16:19]
  ds_read_b64_tr_b16 v[48:49], v9 offset:24576
  ds_read_b64_tr_b16 v[50:51], v9 offset:25088
  v_mfma_f32_16x16x32_bf16 v[32:35], v[64:67], v[180:183], v[32:35]
  ds_read_b64_tr_b16 v[52:53], v10 offset:24576
  ds_read_b64_tr_b16 v[54:55], v10 offset:25088
  v_mfma_f32_16x16x32_bf16 v[20:23], v[68:71], v[176:179], v[20:23]
  ds_read_b64_tr_b16 v[56:57], v11 offset:24576
  ds_read_b64_tr_b16 v[58:59], v11 offset:25088
  v_mfma_f32_16x16x32_bf16 v[36:39], v[68:71], v[180:183], v[36:39]
  ds_read_b64_tr_b16 v[60:61], v12 offset:24576
  ds_read_b64_tr_b16 v[62:63], v12 offset:25088
  v_mfma_f32_16x16x32_bf16 v[24:27], v[72:75], v[176:179], v[24:27]
  v_mfma_f32_16x16x32_bf16 v[40:43], v[72:75], v[180:183], v[40:43]
  v_mfma_f32_16x16x32_bf16 v[28:31], v[76:79], v[176:179], v[28:31]
  v_mfma_f32_16x16x32_bf16 v[44:47], v[76:79], v[180:183], v[44:47]
  s_waitcnt lgkmcnt(0)
  s_waitcnt vmcnt(26)
  v_mfma_f32_16x16x32_bf16 v[16:19], v[48:51], v[184:187], v[16:19]
  ds_read_b64_tr_b16 v[64:65], v9 offset:28672
  ds_read_b64_tr_b16 v[66:67], v9 offset:29184
  v_mfma_f32_16x16x32_bf16 v[32:35], v[48:51], v[188:191], v[32:35]
  ds_read_b64_tr_b16 v[68:69], v10 offset:28672
  ds_read_b64_tr_b16 v[70:71], v10 offset:29184
  v_mfma_f32_16x16x32_bf16 v[20:23], v[52:55], v[184:187], v[20:23]
  ds_read_b64_tr_b16 v[72:73], v11 offset:28672
  ds_read_b64_tr_b16 v[74:75], v11 offset:29184
  v_mfma_f32_16x16x32_bf16 v[36:39], v[52:55], v[188:191], v[36:39]
  ds_read_b64_tr_b16 v[76:77], v12 offset:28672
  ds_read_b64_tr_b16 v[78:79], v12 offset:29184
  v_mfma_f32_16x16x32_bf16 v[24:27], v[56:59], v[184:187], v[24:27]
  v_mfma_f32_16x16x32_bf16 v[40:43], v[56:59], v[188:191], v[40:43]
  v_mfma_f32_16x16x32_bf16 v[28:31], v[60:63], v[184:187], v[28:31]
  v_mfma_f32_16x16x32_bf16 v[44:47], v[60:63], v[188:191], v[44:47]
  s_waitcnt lgkmcnt(0)
  s_waitcnt vmcnt(24)
  v_mfma_f32_16x16x32_bf16 v[16:19], v[64:67], v[192:195], v[16:19]
  ds_read_b64_tr_b16 v[48:49], v9 offset:32768
  ds_read_b64_tr_b16 v[50:51], v9 offset:33280
  v_mfma_f32_16x16x32_bf16 v[32:35], v[64:67], v[196:199], v[32:35]
  ds_read_b64_tr_b16 v[52:53], v10 offset:32768
  ds_read_b64_tr_b16 v[54:55], v10 offset:33280
  v_mfma_f32_16x16x32_bf16 v[20:23], v[68:71], v[192:195], v[20:23]
  ds_read_b64_tr_b16 v[56:57], v11 offset:32768
  ds_read_b64_tr_b16 v[58:59], v11 offset:33280
  v_mfma_f32_16x16x32_bf16 v[36:39], v[68:71], v[196:199], v[36:39]
  ds_read_b64_tr_b16 v[60:61], v12 offset:32768
  ds_read_b64_tr_b16 v[62:63], v12 offset:33280
  v_mfma_f32_16x16x32_bf16 v[24:27], v[72:75], v[192:195], v[24:27]
  v_mfma_f32_16x16x32_bf16 v[40:43], v[72:75], v[196:199], v[40:43]
  v_mfma_f32_16x16x32_bf16 v[28:31], v[76:79], v[192:195], v[28:31]
  v_mfma_f32_16x16x32_bf16 v[44:47], v[76:79], v[196:199], v[44:47]
  s_waitcnt lgkmcnt(0)
  s_waitcnt vmcnt(22)
  v_mfma_f32_16x16x32_bf16 v[16:19], v[48:51], v[200:203], v[16:19]
  ds_read_b64_tr_b16 v[64:65], v9 offset:36864
  ds_read_b64_tr_b16 v[66:67], v9 offset:37376
  v_mfma_f32_16x16x32_bf16 v[32:35], v[48:51], v[204:207], v[32:35]
  ds_read_b64_tr_b16 v[68:69], v10 offset:36864
  ds_read_b64_tr_b16 v[70:71], v10 offset:37376
  v_mfma_f32_16x16x32_bf16 v[20:23], v[52:55], v[200:203], v[20:23]
  ds_read_b64_tr_b16 v[72:73], v11 offset:36864
  ds_read_b64_tr_b16 v[74:75], v11 offset:37376
  v_mfma_f32_16x16x32_bf16 v[36:39], v[52:55], v[204:207], v[36:39]
  ds_read_b64_tr_b16 v[76:77], v12 offset:36864
  ds_read_b64_tr_b16 v[78:79], v12 offset:37376
  v_mfma_f32_16x16x32_bf16 v[24:27], v[56:59], v[200:203], v[24:27]
  v_mfma_f32_16x16x32_bf16 v[40:43], v[56:59], v[204:207], v[40:43]
  v_mfma_f32_16x16x32_bf16 v[28:31], v[60:63], v[200:203], v[28:31]
  v_mfma_f32_16x16x32_bf16 v[44:47], v[60:63], v[204:207], v[44:47]
  s_waitcnt lgkmcnt(0)
  s_waitcnt vmcnt(20)
  v_mfma_f32_16x16x32_bf16 v[16:19], v[64:67], v[208:211], v[16:19]
  ds_read_b64_tr_b16 v[48:49], v80 offset:0
  ds_read_b64_tr_b16 v[50:51], v80 offset:512
  v_mfma_f32_16x16x32_bf16 v[32:35], v[64:67], v[212:215], v[32:35]
  ds_read_b64_tr_b16 v[52:53], v81 offset:0
  ds_read_b64_tr_b16 v[54:55], v81 offset:512
  v_mfma_f32_16x16x32_bf16 v[20:23], v[68:71], v[208:211], v[20:23]
  ds_read_b64_tr_b16 v[56:57], v82 offset:0
  ds_read_b64_tr_b16 v[58:59], v82 offset:512
  v_mfma_f32_16x16x32_bf16 v[36:39], v[68:71], v[212:215], v[36:39]
  ds_read_b64_tr_b16 v[60:61], v83 offset:0
  ds_read_b64_tr_b16 v[62:63], v83 offset:512
  v_mfma_f32_16x16x32_bf16 v[24:27], v[72:75], v[208:211], v[24:27]
  v_mfma_f32_16x16x32_bf16 v[40:43], v[72:75], v[212:215], v[40:43]
  v_mfma_f32_16x16x32_bf16 v[28:31], v[76:79], v[208:211], v[28:31]
  v_mfma_f32_16x16x32_bf16 v[44:47], v[76:79], v[212:215], v[44:47]
  s_waitcnt lgkmcnt(0)
  s_waitcnt vmcnt(18)
  v_mfma_f32_16x16x32_bf16 v[16:19], v[48:51], v[216:219], v[16:19]
  ds_read_b64_tr_b16 v[64:65], v80 offset:4096
  ds_read_b64_tr_b16 v[66:67], v80 offset:4608
  v_mfma_f32_16x16x32_bf16 v[32:35], v[48:51], v[220:223], v[32:35]
  ds_read_b64_tr_b16 v[68:69], v81 offset:4096
  ds_read_b64_tr_b16 v[70:71], v81 offset:4608
  v_mfma_f32_16x16x32_bf16 v[20:23], v[52:55], v[216:219], v[20:23]
  ds_read_b64_tr_b16 v[72:73], v82 offset:4096
  ds_read_b64_tr_b16 v[74:75], v82 offset:4608
  v_mfma_f32_16x16x32_bf16 v[36:39], v[52:55], v[220:223], v[36:39]
  ds_read_b64_tr_b16 v[76:77], v83 offset:4096
  ds_read_b64_tr_b16 v[78:79], v83 offset:4608
  v_mfma_f32_16x16x32_bf16 v[24:27], v[56:59], v[216:219], v[24:27]
  v_mfma_f32_16x16x32_bf16 v[40:43], v[56:59], v[220:223], v[40:43]
  v_mfma_f32_16x16x32_bf16 v[28:31], v[60:63], v[216:219], v[28:31]
  v_mfma_f32_16x16x32_bf16 v[44:47], v[60:63], v[220:223], v[44:47]
  s_waitcnt lgkmcnt(0)
  s_waitcnt vmcnt(16)
  v_mfma_f32_16x16x32_bf16 v[16:19], v[64:67], v[224:227], v[16:19]
  ds_read_b64_tr_b16 v[48:49], v80 offset:8192
  ds_read_b64_tr_b16 v[50:51], v80 offset:8704
  v_mfma_f32_16x16x32_bf16 v[32:35], v[64:67], v[228:231], v[32:35]
  ds_read_b64_tr_b16 v[52:53], v81 offset:8192
  ds_read_b64_tr_b16 v[54:55], v81 offset:8704
  v_mfma_f32_16x16x32_bf16 v[20:23], v[68:71], v[224:227], v[20:23]
  ds_read_b64_tr_b16 v[56:57], v82 offset:8192
  ds_read_b64_tr_b16 v[58:59], v82 offset:8704
  v_mfma_f32_16x16x32_bf16 v[36:39], v[68:71], v[228:231], v[36:39]
  ds_read_b64_tr_b16 v[60:61], v83 offset:8192
  ds_read_b64_tr_b16 v[62:63], v83 offset:8704
  v_mfma_f32_16x16x32_bf16 v[24:27], v[72:75], v[224:227], v[24:27]
  v_mfma_f32_16x16x32_bf16 v[40:43], v[72:75], v[228:231], v[40:43]
  v_mfma_f32_16x16x32_bf16 v[28:31], v[76:79], v[224:227], v[28:31]
  v_mfma_f32_16x16x32_bf16 v[44:47], v[76:79], v[228:231], v[44:47]
  s_waitcnt lgkmcnt(0)
  s_waitcnt vmcnt(14)
  v_mfma_f32_16x16x32_bf16 v[16:19], v[48:51], v[232:235], v[16:19]
  ds_read_b64_tr_b16 v[64:65], v80 offset:12288
  ds_read_b64_tr_b16 v[66:67], v80 offset:12800
  v_mfma_f32_16x16x32_bf16 v[32:35], v[48:51], v[236:239], v[32:35]
  ds_read_b64_tr_b16 v[68:69], v81 offset:12288
  ds_read_b64_tr_b16 v[70:71], v81 offset:12800
  v_mfma_f32_16x16x32_bf16 v[20:23], v[52:55], v[232:235], v[20:23]
  ds_read_b64_tr_b16 v[72:73], v82 offset:12288
  ds_read_b64_tr_b16 v[74:75], v82 offset:12800
  v_mfma_f32_16x16x32_bf16 v[36:39], v[52:55], v[236:239], v[36:39]
  ds_read_b64_tr_b16 v[76:77], v83 offset:12288
  ds_read_b64_tr_b16 v[78:79], v83 offset:12800
  v_mfma_f32_16x16x32_bf16 v[24:27], v[56:59], v[232:235], v[24:27]
  v_mfma_f32_16x16x32_bf16 v[40:43], v[56:59], v[236:239], v[40:43]
  v_mfma_f32_16x16x32_bf16 v[28:31], v[60:63], v[232:235], v[28:31]
  v_mfma_f32_16x16x32_bf16 v[44:47], v[60:63], v[236:239], v[44:47]
  s_waitcnt lgkmcnt(0)
  s_waitcnt vmcnt(12)
  v_mfma_f32_16x16x32_bf16 v[16:19], v[64:67], v[240:243], v[16:19]
  ds_read_b64_tr_b16 v[48:49], v80 offset:16384
  ds_read_b64_tr_b16 v[50:51], v80 offset:16896
  v_mfma_f32_16x16x32_bf16 v[32:35], v[64:67], v[244:247], v[32:35]
  ds_read_b64_tr_b16 v[52:53], v81 offset:16384
  ds_read_b64_tr_b16 v[54:55], v81 offset:16896
  v_mfma_f32_16x16x32_bf16 v[20:23], v[68:71], v[240:243], v[20:23]
  ds_read_b64_tr_b16 v[56:57], v82 offset:16384
  ds_read_b64_tr_b16 v[58:59], v82 offset:16896
  v_mfma_f32_16x16x32_bf16 v[36:39], v[68:71], v[244:247], v[36:39]
  ds_read_b64_tr_b16 v[60:61], v83 offset:16384
  ds_read_b64_tr_b16 v[62:63], v83 offset:16896
  v_mfma_f32_16x16x32_bf16 v[24:27], v[72:75], v[240:243], v[24:27]
  v_mfma_f32_16x16x32_bf16 v[40:43], v[72:75], v[244:247], v[40:43]
  v_mfma_f32_16x16x32_bf16 v[28:31], v[76:79], v[240:243], v[28:31]
  v_mfma_f32_16x16x32_bf16 v[44:47], v[76:79], v[244:247], v[44:47]
  s_waitcnt lgkmcnt(0)
  s_waitcnt vmcnt(10)
  v_mfma_f32_16x16x32_bf16 v[16:19], v[48:51], v[248:251], v[16:19]
  ds_read_b64_tr_b16 v[64:65], v80 offset:20480
  ds_read_b64_tr_b16 v[66:67], v80 offset:20992
  v_mfma_f32_16x16x32_bf16 v[32:35], v[48:51], v[252:255], v[32:35]
  ds_read_b64_tr_b16 v[68:69], v81 offset:20480
  ds_read_b64_tr_b16 v[70:71], v81 offset:20992
  v_mfma_f32_16x16x32_bf16 v[20:23], v[52:55], v[248:251], v[20:23]
  ds_read_b64_tr_b16 v[72:73], v82 offset:20480
  ds_read_b64_tr_b16 v[74:75], v82 offset:20992
  v_mfma_f32_16x16x32_bf16 v[36:39], v[52:55], v[252:255], v[36:39]
  ds_read_b64_tr_b16 v[76:77], v83 offset:20480
  ds_read_b64_tr_b16 v[78:79], v83 offset:20992
  v_mfma_f32_16x16x32_bf16 v[24:27], v[56:59], v[248:251], v[24:27]
  v_mfma_f32_16x16x32_bf16 v[40:43], v[56:59], v[252:255], v[40:43]
  v_mfma_f32_16x16x32_bf16 v[28:31], v[60:63], v[248:251], v[28:31]
  v_mfma_f32_16x16x32_bf16 v[44:47], v[60:63], v[252:255], v[44:47]
  s_waitcnt lgkmcnt(0)
  s_waitcnt vmcnt(8)
  v_mfma_f32_16x16x32_bf16 v[16:19], v[64:67], v[96:99], v[16:19]
  ds_read_b64_tr_b16 v[48:49], v80 offset:24576
  ds_read_b64_tr_b16 v[50:51], v80 offset:25088
  v_mfma_f32_16x16x32_bf16 v[32:35], v[64:67], v[100:103], v[32:35]
  ds_read_b64_tr_b16 v[52:53], v81 offset:24576
  ds_read_b64_tr_b16 v[54:55], v81 offset:25088
  v_mfma_f32_16x16x32_bf16 v[20:23], v[68:71], v[96:99], v[20:23]
  ds_read_b64_tr_b16 v[56:57], v82 offset:24576
  ds_read_b64_tr_b16 v[58:59], v82 offset:25088
  v_mfma_f32_16x16x32_bf16 v[36:39], v[68:71], v[100:103], v[36:39]
  ds_read_b64_tr_b16 v[60:61], v83 offset:24576
  ds_read_b64_tr_b16 v[62:63], v83 offset:25088
  v_mfma_f32_16x16x32_bf16 v[24:27], v[72:75], v[96:99], v[24:27]
  v_mfma_f32_16x16x32_bf16 v[40:43], v[72:75], v[100:103], v[40:43]
  v_mfma_f32_16x16x32_bf16 v[28:31], v[76:79], v[96:99], v[28:31]
  v_mfma_f32_16x16x32_bf16 v[44:47], v[76:79], v[100:103], v[44:47]
  s_waitcnt lgkmcnt(0)
  s_waitcnt vmcnt(6)
  v_mfma_f32_16x16x32_bf16 v[16:19], v[48:51], v[104:107], v[16:19]
  ds_read_b64_tr_b16 v[64:65], v80 offset:28672
  ds_read_b64_tr_b16 v[66:67], v80 offset:29184
  v_mfma_f32_16x16x32_bf16 v[32:35], v[48:51], v[108:111], v[32:35]
  ds_read_b64_tr_b16 v[68:69], v81 offset:28672
  ds_read_b64_tr_b16 v[70:71], v81 offset:29184
  v_mfma_f32_16x16x32_bf16 v[20:23], v[52:55], v[104:107], v[20:23]
  ds_read_b64_tr_b16 v[72:73], v82 offset:28672
  ds_read_b64_tr_b16 v[74:75], v82 offset:29184
  v_mfma_f32_16x16x32_bf16 v[36:39], v[52:55], v[108:111], v[36:39]
  ds_read_b64_tr_b16 v[76:77], v83 offset:28672
  ds_read_b64_tr_b16 v[78:79], v83 offset:29184
  v_mfma_f32_16x16x32_bf16 v[24:27], v[56:59], v[104:107], v[24:27]
  v_mfma_f32_16x16x32_bf16 v[40:43], v[56:59], v[108:111], v[40:43]
  v_mfma_f32_16x16x32_bf16 v[28:31], v[60:63], v[104:107], v[28:31]
  v_mfma_f32_16x16x32_bf16 v[44:47], v[60:63], v[108:111], v[44:47]
  s_waitcnt lgkmcnt(0)
  s_waitcnt vmcnt(4)
  v_mfma_f32_16x16x32_bf16 v[16:19], v[64:67], v[112:115], v[16:19]
  ds_read_b64_tr_b16 v[48:49], v80 offset:32768
  ds_read_b64_tr_b16 v[50:51], v80 offset:33280
  v_mfma_f32_16x16x32_bf16 v[32:35], v[64:67], v[116:119], v[32:35]
  ds_read_b64_tr_b16 v[52:53], v81 offset:32768
  ds_read_b64_tr_b16 v[54:55], v81 offset:33280
  v_mfma_f32_16x16x32_bf16 v[20:23], v[68:71], v[112:115], v[20:23]
  ds_read_b64_tr_b16 v[56:57], v82 offset:32768
  ds_read_b64_tr_b16 v[58:59], v82 offset:33280
  v_mfma_f32_16x16x32_bf16 v[36:39], v[68:71], v[116:119], v[36:39]
  ds_read_b64_tr_b16 v[60:61], v83 offset:32768
  ds_read_b64_tr_b16 v[62:63], v83 offset:33280
  v_mfma_f32_16x16x32_bf16 v[24:27], v[72:75], v[112:115], v[24:27]
  v_mfma_f32_16x16x32_bf16 v[40:43], v[72:75], v[116:119], v[40:43]
  v_mfma_f32_16x16x32_bf16 v[28:31], v[76:79], v[112:115], v[28:31]
  v_mfma_f32_16x16x32_bf16 v[44:47], v[76:79], v[116:119], v[44:47]
  s_waitcnt lgkmcnt(0)
  s_waitcnt vmcnt(2)
  v_mfma_f32_16x16x32_bf16 v[16:19], v[48:51], v[120:123], v[16:19]
  ds_read_b64_tr_b16 v[64:65], v80 offset:36864
  ds_read_b64_tr_b16 v[66:67], v80 offset:37376
  v_mfma_f32_16x16x32_bf16 v[32:35], v[48:51], v[124:127], v[32:35]
  ds_read_b64_tr_b16 v[68:69], v81 offset:36864
  ds_read_b64_tr_b16 v[70:71], v81 offset:37376
  v_mfma_f32_16x16x32_bf16 v[20:23], v[52:55], v[120:123], v[20:23]
  ds_read_b64_tr_b16 v[72:73], v82 offset:36864
  ds_read_b64_tr_b16 v[74:75], v82 offset:37376
  v_mfma_f32_16x16x32_bf16 v[36:39], v[52:55], v[124:127], v[36:39]
  ds_read_b64_tr_b16 v[76:77], v83 offset:36864
  ds_read_b64_tr_b16 v[78:79], v83 offset:37376
  v_mfma_f32_16x16x32_bf16 v[24:27], v[56:59], v[120:123], v[24:27]
  v_mfma_f32_16x16x32_bf16 v[40:43], v[56:59], v[124:127], v[40:43]
  v_mfma_f32_16x16x32_bf16 v[28:31], v[60:63], v[120:123], v[28:31]
  v_mfma_f32_16x16x32_bf16 v[44:47], v[60:63], v[124:127], v[44:47]
  s_waitcnt lgkmcnt(0)
  s_waitcnt vmcnt(0)
  v_mfma_f32_16x16x32_bf16 v[16:19], v[64:67], v[128:131], v[16:19]
  v_mfma_f32_16x16x32_bf16 v[32:35], v[64:67], v[132:135], v[32:35]
  v_mfma_f32_16x16x32_bf16 v[20:23], v[68:71], v[128:131], v[20:23]
  v_mfma_f32_16x16x32_bf16 v[36:39], v[68:71], v[132:135], v[36:39]
  v_mfma_f32_16x16x32_bf16 v[24:27], v[72:75], v[128:131], v[24:27]
  v_mfma_f32_16x16x32_bf16 v[40:43], v[72:75], v[132:135], v[40:43]
  v_mfma_f32_16x16x32_bf16 v[28:31], v[76:79], v[128:131], v[28:31]
  v_mfma_f32_16x16x32_bf16 v[44:47], v[76:79], v[132:135], v[44:47]
  s_barrier
  v_lshrrev_b32 v2, 4, v1
  v_lshlrev_b32 v3, 4, v2
  v_add_u32 v3, 160768, v3
  ds_read_b128 v[48:51], v3 offset:0
  ds_read_b128 v[52:55], v3 offset:64
  ds_read_b128 v[56:59], v3 offset:128
  ds_read_b128 v[60:63], v3 offset:192
  s_waitcnt lgkmcnt(0)
  v_add_f32 v16, v16, v48
  v_add_f32 v17, v17, v49
  v_add_f32 v18, v18, v50
  v_add_f32 v19, v19, v51
  v_cvt_pk_bf16_f32 v64, v16, v17
  v_cvt_pk_bf16_f32 v65, v18, v19
  v_add_f32 v20, v20, v52
  v_add_f32 v21, v21, v53
  v_add_f32 v22, v22, v54
  v_add_f32 v23, v23, v55
  v_cvt_pk_bf16_f32 v66, v20, v21
  v_cvt_pk_bf16_f32 v67, v22, v23
  v_add_f32 v24, v24, v56
  v_add_f32 v25, v25, v57
  v_add_f32 v26, v26, v58
  v_add_f32 v27, v27, v59
  v_cvt_pk_bf16_f32 v68, v24, v25
  v_cvt_pk_bf16_f32 v69, v26, v27
  v_add_f32 v28, v28, v60
  v_add_f32 v29, v29, v61
  v_add_f32 v30, v30, v62
  v_add_f32 v31, v31, v63
  v_cvt_pk_bf16_f32 v70, v28, v29
  v_cvt_pk_bf16_f32 v71, v30, v31
  v_add_f32 v32, v32, v48
  v_add_f32 v33, v33, v49
  v_add_f32 v34, v34, v50
  v_add_f32 v35, v35, v51
  v_cvt_pk_bf16_f32 v72, v32, v33
  v_cvt_pk_bf16_f32 v73, v34, v35
  v_add_f32 v36, v36, v52
  v_add_f32 v37, v37, v53
  v_add_f32 v38, v38, v54
  v_add_f32 v39, v39, v55
  v_cvt_pk_bf16_f32 v74, v36, v37
  v_cvt_pk_bf16_f32 v75, v38, v39
  v_add_f32 v40, v40, v56
  v_add_f32 v41, v41, v57
  v_add_f32 v42, v42, v58
  v_add_f32 v43, v43, v59
  v_cvt_pk_bf16_f32 v76, v40, v41
  v_cvt_pk_bf16_f32 v77, v42, v43
  v_add_f32 v44, v44, v60
  v_add_f32 v45, v45, v61
  v_add_f32 v46, v46, v62
  v_add_f32 v47, v47, v63
  v_cvt_pk_bf16_f32 v78, v44, v45
  v_cvt_pk_bf16_f32 v79, v46, v47
  s_lshl_b32 s44, s53, 3
  s_add_u32 s56, s44, s52
  s_mul_i32 s44, s56, 24576
  s_mul_i32 s45, s54, 3072
  s_add_u32 s44, s44, s45
  s_add_u32 s44, s44, 4194304
  v_lshlrev_b32 v7, 4, v1
  v_lshlrev_b32 v8, 3, v1
  buffer_store_dwordx4 v[68:71], v7, s[24:27], s44 offen offset:0 sc0 sc1
  buffer_store_dwordx2 v[66:67], v8, s[24:27], s44 offen offset:1024 sc0 sc1
  buffer_store_dwordx4 v[76:79], v7, s[24:27], s44 offen offset:1536 sc0 sc1
  buffer_store_dwordx2 v[74:75], v8, s[24:27], s44 offen offset:2560 sc0 sc1
  v_and_b32 v4, 15, v1
  v_bfe_u32 v5, v1, 2, 1
  v_lshlrev_b32 v5, 2, v5
  v_add_u32 v6, -1, v2
  v_cmp_eq_u32 vcc, 0, v2
  s_nop 1
  v_cndmask_b32 v6, v6, 6, vcc
  v_add_u32 v9, 2, v2
  v_cndmask_b32 v9, v9, 7, vcc
  v_xor_b32 v6, v6, v5
  v_xor_b32 v9, v9, v5
  v_lshlrev_b32 v4, 6, v4
  v_lshl_add_u32 v6, v6, 3, v4
  v_lshl_add_u32 v9, v9, 3, v4
  s_lshl_b32 s45, s54, 11
  v_add_u32 v6, s45, v6
  v_add_u32 v9, s45, v9
  v_add_u32 v10, s45, v7
  v_add_u32 v6, 114688, v6
  v_add_u32 v9, 114688, v9
  v_add_u32 v10, 81920, v10
  v_cmp_eq_u32 s[58:59], 3, v2
  v_mov_b32 v11, 0x3f803f80
  ds_write_b128 v10, v[68:71] offset:16384
  ds_write_b64 v6, v[66:67] offset:16384
  v_cndmask_b32 v12, v70, v11, s[58:59]
  v_cndmask_b32 v13, v71, v11, s[58:59]
  ds_write_b64 v9, v[12:13] offset:16384
  ds_write_b128 v10, v[76:79] offset:17408
  ds_write_b64 v6, v[74:75] offset:17408
  v_cndmask_b32 v12, v78, v11, s[58:59]
  v_cndmask_b32 v13, v79, v11, s[58:59]
  ds_write_b64 v9, v[12:13] offset:17408
  v_cmp_eq_u32 vcc, 0, v2
  s_nop 1
  v_cndmask_b32 v66, 0, v66, vcc
  v_cndmask_b32 v67, 0, v67, vcc
  v_cndmask_b32 v74, 0, v74, vcc
  v_cndmask_b32 v75, 0, v75, vcc
  s_waitcnt vmcnt(0)
  s_barrier
  s_cmp_lg_u32 s43, 0
  s_cbranch_scc1 L_noflag_20
  s_lshl_b32 s44, s56, 6
  s_add_u32 s44, s44, 16384
  s_mov_b32 exec_lo, 1
  s_mov_b32 exec_hi, 0
  v_mov_b32 v2, s44
  v_mov_b32 v3, s42
  buffer_store_dword v3, v2, s[24:27], 0 offen sc0 sc1
  s_mov_b64 exec, -1
L_noflag_20:
  s_cmp_lg_u32 s43, 7
  s_cbranch_scc1 L_nofin_21
  v_add_f32 v84, v84, v85
  v_add_f32 v86, v86, v87
  v_cvt_pk_bf16_f32 v84, v84, v86
  v_lshlrev_b32 v85, 16, v84
  v_and_b32 v86, 0xffff0000, v84
  v_add_f32 v85, 1.0, v85
  v_add_f32 v86, 1.0, v86
  v_cvt_pk_bf16_f32 v85, v85, v86
  s_lshr_b32 s44, s53, 3
  s_cmp_eq_u32 s44, 2
  s_cselect_b64 vcc, -1, 0
  v_cndmask_b32 v84, v84, v85, vcc
  v_lshrrev_b32 v85, 16, v84
  s_lshl_b32 s44, s52, 13
  s_mul_i32 s45, s53, 160
  s_add_u32 s44, s44, s45
  s_add_u32 s44, s44, 199168
  v_lshlrev_b32 v86, 1, v1
  buffer_store_short v84, v86, s[24:27], s44 offen sc0 sc1
  s_mov_b32 exec_lo, 65535
  s_mov_b32 exec_hi, 0
  buffer_store_short v85, v86, s[24:27], s44 offen offset:128 sc0 sc1
  s_mov_b64 exec, -1
L_nofin_21:
  s_sub_u32 s57, s56, 1
  s_cmp_eq_u32 s52, 0
  s_cselect_b32 s57, s56, s57
  s_sub_u32 s73, s43, 4
  s_lshl_b32 s73, s73, 8
  s_add_u32 s73, s73, s2
  s_cmp_lt_u32 s73, 432
  s_cselect_b32 s74, 1, 0
  v_mov_b32 v16, 0
  v_mov_b32 v17, 0
  v_mov_b32 v18, 0
  v_mov_b32 v19, 0
  v_mov_b32 v20, 0
  v_mov_b32 v21, 0
  s_cmp_eq_u32 s74, 0
  s_nop 0
  s_cbranch_scc1 L_noprep_22
  v_add_u32 v24, 0, v1
  v_mul_u32_u24 v25, 745, v24
  v_lshrrev_b32 v25, 16, v25
  v_mul_u32_u24 v26, 88, v25
  v_sub_u32 v24, v24, v26
  v_cmp_gt_u32 vcc, 80, v24
  s_nop 1
  v_cndmask_b32 v24, 0, v24, vcc
  v_mul_u32_u24 v26, 103, v24
  v_lshrrev_b32 v26, 10, v26
  v_mul_u32_u24 v27, 10, v26
  v_sub_u32 v24, v24, v27
  v_lshl_add_u32 v27, v25, 3, v26
  s_mov_b32 s44, 1280
  v_mul_lo_u32 v27, v27, s44
  v_lshl_add_u32 v16, v24, 4, v27
  v_add_u32 v24, 64, v1
  v_mul_u32_u24 v25, 745, v24
  v_lshrrev_b32 v25, 16, v25
  v_mul_u32_u24 v26, 88, v25
  v_sub_u32 v24, v24, v26
  v_cmp_gt_u32 vcc, 80, v24
  s_nop 1
  v_cndmask_b32 v24, 0, v24, vcc
  v_mul_u32_u24 v26, 103, v24
  v_lshrrev_b32 v26, 10, v26
  v_mul_u32_u24 v27, 10, v26
  v_sub_u32 v24, v24, v27
  v_lshl_add_u32 v27, v25, 3, v26
  s_mov_b32 s44, 1280
  v_mul_lo_u32 v27, v27, s44
  v_lshl_add_u32 v17, v24, 4, v27
  v_add_u32 v24, 128, v1
  v_mul_u32_u24 v25, 745, v24
  v_lshrrev_b32 v25, 16, v25
  v_mul_u32_u24 v26, 88, v25
  v_sub_u32 v24, v24, v26
  v_cmp_gt_u32 vcc, 80, v24
  s_nop 1
  v_cndmask_b32 v24, 0, v24, vcc
  v_mul_u32_u24 v26, 103, v24
  v_lshrrev_b32 v26, 10, v26
  v_mul_u32_u24 v27, 10, v26
  v_sub_u32 v24, v24, v27
  v_lshl_add_u32 v27, v25, 3, v26
  s_mov_b32 s44, 1280
  v_mul_lo_u32 v27, v27, s44
  v_lshl_add_u32 v18, v24, 4, v27
  v_add_u32 v24, 192, v1
  v_mul_u32_u24 v25, 745, v24
  v_lshrrev_b32 v25, 16, v25
  v_mul_u32_u24 v26, 88, v25
  v_sub_u32 v24, v24, v26
  v_cmp_gt_u32 vcc, 80, v24
  s_nop 1
  v_cndmask_b32 v24, 0, v24, vcc
  v_mul_u32_u24 v26, 103, v24
  v_lshrrev_b32 v26, 10, v26
  v_mul_u32_u24 v27, 10, v26
  v_sub_u32 v24, v24, v27
  v_lshl_add_u32 v27, v25, 3, v26
  s_mov_b32 s44, 1280
  v_mul_lo_u32 v27, v27, s44
  v_lshl_add_u32 v19, v24, 4, v27
  v_add_u32 v24, 256, v1
  v_mul_u32_u24 v25, 745, v24
  v_lshrrev_b32 v25, 16, v25
  v_mul_u32_u24 v26, 88, v25
  v_sub_u32 v24, v24, v26
  v_cmp_gt_u32 vcc, 80, v24
  s_nop 1
  v_cndmask_b32 v24, 0, v24, vcc
  v_mul_u32_u24 v26, 103, v24
  v_lshrrev_b32 v26, 10, v26
  v_mul_u32_u24 v27, 10, v26
  v_sub_u32 v24, v24, v27
  v_lshl_add_u32 v27, v25, 3, v26
  s_mov_b32 s44, 1280
  v_mul_lo_u32 v27, v27, s44
  v_lshl_add_u32 v20, v24, 4, v27
  v_add_u32 v24, 320, v1
  v_mul_u32_u24 v25, 745, v24
  v_lshrrev_b32 v25, 16, v25
  v_mul_u32_u24 v26, 88, v25
  v_sub_u32 v24, v24, v26
  v_cmp_gt_u32 vcc, 80, v24
  s_nop 1
  v_cndmask_b32 v24, 0, v24, vcc
  v_mul_u32_u24 v26, 103, v24
  v_lshrrev_b32 v26, 10, v26
  v_mul_u32_u24 v27, 10, v26
  v_sub_u32 v24, v24, v27
  v_lshl_add_u32 v27, v25, 3, v26
  s_mov_b32 s44, 1280
  v_mul_lo_u32 v27, v27, s44
  v_lshl_add_u32 v21, v24, 4, v27
  s_nop 1
L_noprep_22:
  s_lshl_b32 s44, s40, 4
  s_and_b32 s45, s41, 3
  s_lshl_b32 s45, s45, 2
  s_add_u32 s60, s44, s45
  s_lshr_b32 s61, s41, 2
  s_and_b32 s62, s43, 1
  s_lshr_b32 s63, s43, 1
  s_cmp_eq_u32 s62, 1
  s_cselect_b32 s65, 0, -1
  s_mov_b32 s64, -1
  s_mul_i32 s66, s62, 192
  s_mul_i32 s44, s61, 160
  s_add_u32 s28, s8, s44
  s_addc_u32 s29, s9, 0
  s_mov_b32 s30, 819200
  s_mov_b32 s31, 0x20000
  s_sub_u32 s30, s30, s44
  s_add_u32 s67, s66, 0
  s_add_u32 s68, s66, 64
  s_add_u32 s69, s66, 128
  v_add_u32 v105, s67, v1
  v_mul_u32_u24 v106, 745, v105
  v_lshrrev_b32 v106, 16, v106
  v_mul_u32_u24 v107, 88, v106
  v_sub_u32 v105, v105, v107
  v_cmp_gt_u32 vcc, 80, v105
  s_nop 1
  v_cndmask_b32 v105, 0, v105, vcc
  v_mul_u32_u24 v107, 103, v105
  v_lshrrev_b32 v107, 10, v107
  v_mul_u32_u24 v108, 10, v107
  v_sub_u32 v105, v105, v108
  v_add_u32 v106, 0, v106
  v_mul_u32_u24 v108, 86, v106
  v_lshrrev_b32 v108, 8, v108
  v_mul_u32_u24 v109, 3, v108
  v_sub_u32 v109, v106, v109
  v_and_b32 v110, 3, v107
  v_cmp_eq_u32 vcc, 2, v109
  s_nop 1
  v_cndmask_b32 v107, v107, v110, vcc
  v_mul_u32_u24 v108, 20, v108
  v_lshl_add_u32 v108, v109, 3, v108
  v_add_u32 v108, v108, v107
  s_mov_b32 s44, 1280
  v_mul_lo_u32 v108, v108, s44
  v_lshl_add_u32 v96, v105, 4, v108
  v_add_u32 v105, s68, v1
  v_mul_u32_u24 v106, 745, v105
  v_lshrrev_b32 v106, 16, v106
  v_mul_u32_u24 v107, 88, v106
  v_sub_u32 v105, v105, v107
  v_cmp_gt_u32 vcc, 80, v105
  s_nop 1
  v_cndmask_b32 v105, 0, v105, vcc
  v_mul_u32_u24 v107, 103, v105
  v_lshrrev_b32 v107, 10, v107
  v_mul_u32_u24 v108, 10, v107
  v_sub_u32 v105, v105, v108
  v_add_u32 v106, 0, v106
  v_mul_u32_u24 v108, 86, v106
  v_lshrrev_b32 v108, 8, v108
  v_mul_u32_u24 v109, 3, v108
  v_sub_u32 v109, v106, v109
  v_and_b32 v110, 3, v107
  v_cmp_eq_u32 vcc, 2, v109
  s_nop 1
  v_cndmask_b32 v107, v107, v110, vcc
  v_mul_u32_u24 v108, 20, v108
  v_lshl_add_u32 v108, v109, 3, v108
  v_add_u32 v108, v108, v107
  s_mov_b32 s44, 1280
  v_mul_lo_u32 v108, v108, s44
  v_lshl_add_u32 v97, v105, 4, v108
  v_add_u32 v105, s69, v1
  v_mul_u32_u24 v106, 745, v105
  v_lshrrev_b32 v106, 16, v106
  v_mul_u32_u24 v107, 88, v106
  v_sub_u32 v105, v105, v107
  v_cmp_gt_u32 vcc, 80, v105
  s_nop 1
  v_cndmask_b32 v105, 0, v105, vcc
  v_mul_u32_u24 v107, 103, v105
  v_lshrrev_b32 v107, 10, v107
  v_mul_u32_u24 v108, 10, v107
  v_sub_u32 v105, v105, v108
  v_add_u32 v106, 0, v106
  v_mul_u32_u24 v108, 86, v106
  v_lshrrev_b32 v108, 8, v108
  v_mul_u32_u24 v109, 3, v108
  v_sub_u32 v109, v106, v109
  v_and_b32 v110, 3, v107
  v_cmp_eq_u32 vcc, 2, v109
  s_nop 1
  v_cndmask_b32 v107, v107, v110, vcc
  v_mul_u32_u24 v108, 20, v108
  v_lshl_add_u32 v108, v109, 3, v108
  v_add_u32 v108, v108, v107
  s_mov_b32 s44, 1280
  v_mul_lo_u32 v108, v108, s44
  v_lshl_add_u32 v98, v105, 4, v108
  v_add_u32 v105, s67, v1
  v_mul_u32_u24 v106, 745, v105
  v_lshrrev_b32 v106, 16, v106
  v_mul_u32_u24 v107, 88, v106
  v_sub_u32 v105, v105, v107
  v_cmp_gt_u32 vcc, 80, v105
  s_nop 1
  v_cndmask_b32 v105, 0, v105, vcc
  v_mul_u32_u24 v107, 103, v105
  v_lshrrev_b32 v107, 10, v107
  v_mul_u32_u24 v108, 10, v107
  v_sub_u32 v105, v105, v108
  v_add_u32 v106, 4, v106
  v_mul_u32_u24 v108, 86, v106
  v_lshrrev_b32 v108, 8, v108
  v_mul_u32_u24 v109, 3, v108
  v_sub_u32 v109, v106, v109
  v_and_b32 v110, 3, v107
  v_cmp_eq_u32 vcc, 2, v109
  s_nop 1
  v_cndmask_b32 v107, v107, v110, vcc
  v_mul_u32_u24 v108, 20, v108
  v_lshl_add_u32 v108, v109, 3, v108
  v_add_u32 v108, v108, v107
  s_mov_b32 s44, 1280
  v_mul_lo_u32 v108, v108, s44
  v_lshl_add_u32 v99, v105, 4, v108
  v_add_u32 v105, s68, v1
  v_mul_u32_u24 v106, 745, v105
  v_lshrrev_b32 v106, 16, v106
  v_mul_u32_u24 v107, 88, v106
  v_sub_u32 v105, v105, v107
  v_cmp_gt_u32 vcc, 80, v105
  s_nop 1
  v_cndmask_b32 v105, 0, v105, vcc
  v_mul_u32_u24 v107, 103, v105
  v_lshrrev_b32 v107, 10, v107
  v_mul_u32_u24 v108, 10, v107
  v_sub_u32 v105, v105, v108
  v_add_u32 v106, 4, v106
  v_mul_u32_u24 v108, 86, v106
  v_lshrrev_b32 v108, 8, v108
  v_mul_u32_u24 v109, 3, v108
  v_sub_u32 v109, v106, v109
  v_and_b32 v110, 3, v107
  v_cmp_eq_u32 vcc, 2, v109
  s_nop 1
  v_cndmask_b32 v107, v107, v110, vcc
  v_mul_u32_u24 v108, 20, v108
  v_lshl_add_u32 v108, v109, 3, v108
  v_add_u32 v108, v108, v107
  s_mov_b32 s44, 1280
  v_mul_lo_u32 v108, v108, s44
  v_lshl_add_u32 v100, v105, 4, v108
  v_add_u32 v105, s69, v1
  v_mul_u32_u24 v106, 745, v105
  v_lshrrev_b32 v106, 16, v106
  v_mul_u32_u24 v107, 88, v106
  v_sub_u32 v105, v105, v107
  v_cmp_gt_u32 vcc, 80, v105
  s_nop 1
  v_cndmask_b32 v105, 0, v105, vcc
  v_mul_u32_u24 v107, 103, v105
  v_lshrrev_b32 v107, 10, v107
  v_mul_u32_u24 v108, 10, v107
  v_sub_u32 v105, v105, v108
  v_add_u32 v106, 4, v106
  v_mul_u32_u24 v108, 86, v106
  v_lshrrev_b32 v108, 8, v108
  v_mul_u32_u24 v109, 3, v108
  v_sub_u32 v109, v106, v109
  v_and_b32 v110, 3, v107
  v_cmp_eq_u32 vcc, 2, v109
  s_nop 1
  v_cndmask_b32 v107, v107, v110, vcc
  v_mul_u32_u24 v108, 20, v108
  v_lshl_add_u32 v108, v109, 3, v108
  v_add_u32 v108, v108, v107
  s_mov_b32 s44, 1280
  v_mul_lo_u32 v108, v108, s44
  v_lshl_add_u32 v101, v105, 4, v108
  v_add_u32 v105, s67, v1
  v_mul_u32_u24 v106, 745, v105
  v_lshrrev_b32 v106, 16, v106
  v_mul_u32_u24 v107, 88, v106
  v_sub_u32 v105, v105, v107
  v_cmp_gt_u32 vcc, 80, v105
  s_nop 1
  v_cndmask_b32 v105, 0, v105, vcc
  v_mul_u32_u24 v107, 103, v105
  v_lshrrev_b32 v107, 10, v107
  v_mul_u32_u24 v108, 10, v107
  v_sub_u32 v105, v105, v108
  v_add_u32 v106, 8, v106
  v_mul_u32_u24 v108, 86, v106
  v_lshrrev_b32 v108, 8, v108
  v_mul_u32_u24 v109, 3, v108
  v_sub_u32 v109, v106, v109
  v_and_b32 v110, 3, v107
  v_cmp_eq_u32 vcc, 2, v109
  s_nop 1
  v_cndmask_b32 v107, v107, v110, vcc
  v_mul_u32_u24 v108, 20, v108
  v_lshl_add_u32 v108, v109, 3, v108
  v_add_u32 v108, v108, v107
  s_mov_b32 s44, 1280
  v_mul_lo_u32 v108, v108, s44
  v_lshl_add_u32 v102, v105, 4, v108
  v_add_u32 v105, s68, v1
  v_mul_u32_u24 v106, 745, v105
  v_lshrrev_b32 v106, 16, v106
  v_mul_u32_u24 v107, 88, v106
  v_sub_u32 v105, v105, v107
  v_cmp_gt_u32 vcc, 80, v105
  s_nop 1
  v_cndmask_b32 v105, 0, v105, vcc
  v_mul_u32_u24 v107, 103, v105
  v_lshrrev_b32 v107, 10, v107
  v_mul_u32_u24 v108, 10, v107
  v_sub_u32 v105, v105, v108
  v_add_u32 v106, 8, v106
  v_mul_u32_u24 v108, 86, v106
  v_lshrrev_b32 v108, 8, v108
  v_mul_u32_u24 v109, 3, v108
  v_sub_u32 v109, v106, v109
  v_and_b32 v110, 3, v107
  v_cmp_eq_u32 vcc, 2, v109
  s_nop 1
  v_cndmask_b32 v107, v107, v110, vcc
  v_mul_u32_u24 v108, 20, v108
  v_lshl_add_u32 v108, v109, 3, v108
  v_add_u32 v108, v108, v107
  s_mov_b32 s44, 1280
  v_mul_lo_u32 v108, v108, s44
  v_lshl_add_u32 v103, v105, 4, v108
  v_add_u32 v105, s69, v1
  v_mul_u32_u24 v106, 745, v105
  v_lshrrev_b32 v106, 16, v106
  v_mul_u32_u24 v107, 88, v106
  v_sub_u32 v105, v105, v107
  v_cmp_gt_u32 vcc, 80, v105
  s_nop 1
  v_cndmask_b32 v105, 0, v105, vcc
  v_mul_u32_u24 v107, 103, v105
  v_lshrrev_b32 v107, 10, v107
  v_mul_u32_u24 v108, 10, v107
  v_sub_u32 v105, v105, v108
  v_add_u32 v106, 8, v106
  v_mul_u32_u24 v108, 86, v106
  v_lshrrev_b32 v108, 8, v108
  v_mul_u32_u24 v109, 3, v108
  v_sub_u32 v109, v106, v109
  v_and_b32 v110, 3, v107
  v_cmp_eq_u32 vcc, 2, v109
  s_nop 1
  v_cndmask_b32 v107, v107, v110, vcc
  v_mul_u32_u24 v108, 20, v108
  v_lshl_add_u32 v108, v109, 3, v108
  v_add_u32 v108, v108, v107
  s_mov_b32 s44, 1280
  v_mul_lo_u32 v108, v108, s44
  v_lshl_add_u32 v104, v105, 4, v108
  s_bfe_u32 s44, s43, 0x10001
  s_lshr_b32 s45, s43, 2
  s_mul_i32 s70, s44, 33792
  s_mul_i32 s47, s45, 16896
  s_add_u32 s70, s70, s47
  s_mul_i32 s47, s62, 3072
  s_add_u32 s70, s70, s47
  s_mul_i32 s71, s44, 204800
  s_mul_i32 s47, s45, 102400
  s_add_u32 s71, s71, s47
  s_cmp_lg_u32 s43, 0
  s_cbranch_scc1 L_nowait_23
  v_mov_b32 v4, s57
  v_lshlrev_b32 v4, 6, v4
  v_add_u32 v4, 16384, v4
  s_mov_b32 s44, 40000
  s_nop 0
L_poll_24:
  buffer_load_dword v8, v4, s[24:27], 0 offen sc0 sc1
  s_waitcnt vmcnt(0)
  v_cmp_ne_u32 vcc, s42, v8
  s_cmp_eq_u64 vcc, 0
  s_nop 3
  s_cbranch_scc1 L_polld_25
  s_sub_u32 s44, s44, 1
  s_cmp_lg_u32 s44, 0
  s_cbranch_scc1 L_poll_24
L_polld_25:
L_nowait_23:
  s_barrier
  s_mul_i32 s44, s57, 24576
  s_mul_i32 s45, s54, 3072
  s_add_u32 s44, s44, s45
  s_add_u32 s44, s44, 4194304
  v_lshlrev_b32 v8, 3, v1
  buffer_load_dwordx4 v[80:83], v7, s[24:27], s44 offen offset:0
  buffer_load_dwordx2 v[84:85], v8, s[24:27], s44 offen offset:1024
  buffer_load_dwordx4 v[88:91], v7, s[24:27], s44 offen offset:1536
  buffer_load_dwordx2 v[92:93], v8, s[24:27], s44 offen offset:2560
  s_cmp_eq_u32 s74, 0
  s_cbranch_scc1 L_nojob_27
  s_mul_i32 s44, s73, 1214
  s_lshr_b32 s44, s44, 16
  s_mul_i32 s45, s44, 54
  s_sub_u32 s45, s73, s45
  s_mul_i32 s45, s45, 40960
  s_mul_i32 s44, s44, 160
  s_add_u32 s36, s16, s44
  s_addc_u32 s37, s17, 0
  s_mov_b32 s38, 2211840
  s_mov_b32 s39, 0x20000
  s_sub_u32 s38, s38, s44
  s_sub_u32 s46, s43, 4
  s_mul_i32 s46, s46, 5632
  s_add_u32 s46, s46, 67584
  s_add_u32 m0, s46, 0
  s_nop 0
  buffer_load_dwordx4 v16, s[36:39], s45 offen lds
  s_add_u32 m0, s46, 1024
  s_nop 0
  buffer_load_dwordx4 v17, s[36:39], s45 offen lds
  s_add_u32 m0, s46, 2048
  s_nop 0
  buffer_load_dwordx4 v18, s[36:39], s45 offen lds
  s_add_u32 m0, s46, 3072
  s_nop 0
  buffer_load_dwordx4 v19, s[36:39], s45 offen lds
  s_add_u32 m0, s46, 4096
  s_nop 0
  buffer_load_dwordx4 v20, s[36:39], s45 offen lds
  s_add_u32 m0, s46, 5120
  s_mov_b32 exec_lo, -1
  s_mov_b32 exec_hi, 0
  buffer_load_dwordx4 v21, s[36:39], s45 offen lds
  s_mov_b64 exec, -1
  s_waitcnt vmcnt(6)
  s_branch L_jobd_28
L_nojob_27:
  s_waitcnt vmcnt(0)
L_jobd_28:
  ds_write_b128 v10, v[80:83] offset:0
  ds_write_b64 v6, v[84:85] offset:0
  v_cndmask_b32 v12, v82, v11, s[58:59]
  v_cndmask_b32 v13, v83, v11, s[58:59]
  ds_write_b64 v9, v[12:13] offset:0
  ds_write_b128 v10, v[88:91] offset:1024
  ds_write_b64 v6, v[92:93] offset:1024
  v_cndmask_b32 v12, v90, v11, s[58:59]
  v_cndmask_b32 v13, v91, v11, s[58:59]
  ds_write_b64 v9, v[12:13] offset:1024
  s_waitcnt lgkmcnt(0)
  s_barrier
  s_lshl_b32 s44, s43, 5
  s_add_u32 s44, s44, s41
  s_lshl_b32 s44, s44, 6
  v_add_u32 v105, s44, v1
  s_and_b32 s44, s40, 3
  s_mul_i32 s44, s44, 13
  s_lshr_b32 s44, s44, 1
  s_lshl_b32 s44, s44, 7
  s_mov_b32 s32, s12
  s_mov_b32 s33, s13
  s_mov_b32 s34, 2211840
  s_mov_b32 s35, 0x20000
  v_subrev_u32 v106, 0, v105
  v_lshrrev_b32 v107, 3, v106
  v_and_b32 v106, 7, v106
  v_mul_u32_u24 v107, 3456, v107
  v_lshl_add_u32 v106, v106, 7, v107
  v_subrev_u32 v107, 0, v105
  v_cmp_gt_u32 vcc, 5120, v107
  s_nop 1
  v_cndmask_b32 v106, -1, v106, vcc
  v_and_b32 v106, 0x7fffffff, v106
  buffer_load_dword v110, v106, s[32:35], s44 offen
  s_mov_b32 s32, s14
  s_mov_b32 s33, s15
  s_mov_b32 s34, 2211840
  s_mov_b32 s35, 0x20000
  v_subrev_u32 v106, 5120, v105
  v_lshrrev_b32 v107, 3, v106
  v_and_b32 v106, 7, v106
  v_mul_u32_u24 v107, 3456, v107
  v_lshl_add_u32 v106, v106, 7, v107
  v_subrev_u32 v107, 5120, v105
  v_cmp_gt_u32 vcc, 5120, v107
  s_nop 1
  v_cndmask_b32 v106, -1, v106, vcc
  v_and_b32 v106, 0x7fffffff, v106
  buffer_load_dword v111, v106, s[32:35], s44 offen
  s_lshl_b32 s45, s54, 11
  v_lshlrev_b32 v7, 4, v1
  v_add_u32 v7, s45, v7
  v_add_u32 v7, 81920, v7
  ds_read_b128 v[80:83], v7 offset:0
  ds_read_b128 v[84:87], v7 offset:1024
  s_waitcnt lgkmcnt(0)
  v_mfma_f32_16x16x32_bf16 v[112:115], v[80:83], v[64:67], 0
  v_mfma_f32_16x16x32_bf16 v[120:123], v[84:87], v[64:67], 0
  v_mfma_f32_16x16x32_bf16 v[124:127], v[84:87], v[72:75], 0
  ds_read_b128 v[88:91], v7 offset:2048
  ds_read_b128 v[92:95], v7 offset:3072
  s_waitcnt lgkmcnt(0)
  v_mfma_f32_16x16x32_bf16 v[128:131], v[88:91], v[64:67], 0
  v_mfma_f32_16x16x32_bf16 v[132:135], v[88:91], v[72:75], 0
  v_mfma_f32_16x16x32_bf16 v[136:139], v[92:95], v[64:67], 0
  v_mfma_f32_16x16x32_bf16 v[140:143], v[92:95], v[72:75], 0
  ds_read_b128 v[80:83], v7 offset:4096
  ds_read_b128 v[84:87], v7 offset:5120
  s_waitcnt lgkmcnt(0)
  v_mfma_f32_16x16x32_bf16 v[144:147], v[80:83], v[64:67], 0
  v_mfma_f32_16x16x32_bf16 v[148:151], v[80:83], v[72:75], 0
  v_mfma_f32_16x16x32_bf16 v[152:155], v[84:87], v[64:67], 0
  v_mfma_f32_16x16x32_bf16 v[156:159], v[84:87], v[72:75], 0
  ds_read_b128 v[88:91], v7 offset:6144
  ds_read_b128 v[92:95], v7 offset:7168
  s_waitcnt lgkmcnt(0)
  v_mfma_f32_16x16x32_bf16 v[160:163], v[88:91], v[64:67], 0
  v_mfma_f32_16x16x32_bf16 v[164:167], v[88:91], v[72:75], 0
  v_mfma_f32_16x16x32_bf16 v[168:171], v[92:95], v[64:67], 0
  v_mfma_f32_16x16x32_bf16 v[172:175], v[92:95], v[72:75], 0
  ds_read_b128 v[80:83], v7 offset:8192
  ds_read_b128 v[84:87], v7 offset:9216
  s_waitcnt lgkmcnt(0)
  v_mfma_f32_16x16x32_bf16 v[176:179], v[80:83], v[64:67], 0
  v_mfma_f32_16x16x32_bf16 v[180:183], v[80:83], v[72:75], 0
  v_mfma_f32_16x16x32_bf16 v[184:187], v[84:87], v[64:67], 0
  v_mfma_f32_16x16x32_bf16 v[188:191], v[84:87], v[72:75], 0
  ds_read_b128 v[88:91], v7 offset:10240
  ds_read_b128 v[92:95], v7 offset:11264
  s_waitcnt lgkmcnt(0)
  v_mfma_f32_16x16x32_bf16 v[192:195], v[88:91], v[64:67], 0
  v_mfma_f32_16x16x32_bf16 v[196:199], v[88:91], v[72:75], 0
  v_mfma_f32_16x16x32_bf16 v[200:203], v[92:95], v[64:67], 0
  v_mfma_f32_16x16x32_bf16 v[204:207], v[92:95], v[72:75], 0
  ds_read_b128 v[80:83], v7 offset:12288
  ds_read_b128 v[84:87], v7 offset:13312
  s_waitcnt lgkmcnt(0)
  v_mfma_f32_16x16x32_bf16 v[208:211], v[80:83], v[64:67], 0
  v_mfma_f32_16x16x32_bf16 v[212:215], v[80:83], v[72:75], 0
  v_mfma_f32_16x16x32_bf16 v[216:219], v[84:87], v[64:67], 0
  v_mfma_f32_16x16x32_bf16 v[220:223], v[84:87], v[72:75], 0
  ds_read_b128 v[88:91], v7 offset:14336
  ds_read_b128 v[92:95], v7 offset:15360
  s_waitcnt lgkmcnt(0)
  v_mfma_f32_16x16x32_bf16 v[224:227], v[88:91], v[64:67], 0
  v_mfma_f32_16x16x32_bf16 v[228:231], v[88:91], v[72:75], 0
  v_mfma_f32_16x16x32_bf16 v[232:235], v[92:95], v[64:67], 0
  v_mfma_f32_16x16x32_bf16 v[236:239], v[92:95], v[72:75], 0
  ds_read_b128 v[80:83], v7 offset:16384
  ds_read_b128 v[84:87], v7 offset:17408
  s_waitcnt lgkmcnt(0)
  v_mfma_f32_16x16x32_bf16 v[240:243], v[80:83], v[64:67], 0
  v_mfma_f32_16x16x32_bf16 v[244:247], v[80:83], v[72:75], 0
  v_mfma_f32_16x16x32_bf16 v[252:255], v[84:87], v[72:75], 0
  v_and_b32 v4, 15, v1
  v_lshrrev_b32 v2, 4, v1
  v_lshlrev_b32 v5, 2, v2
  v_sub_u32 v5, v4, v5
  v_mov_b32 v6, 0xf149f2ca
  v_cmp_le_i32 vcc, 0, v5
  s_nop 1
  v_cndmask_b32 v240, v6, v240, vcc
  v_cndmask_b32 v112, v112, v6, vcc
  v_cndmask_b32 v252, v6, v252, vcc
  v_cndmask_b32 v124, v124, v6, vcc
  v_cmp_le_i32 vcc, 1, v5
  s_nop 1
  v_cndmask_b32 v241, v6, v241, vcc
  v_cndmask_b32 v113, v113, v6, vcc
  v_cndmask_b32 v253, v6, v253, vcc
  v_cndmask_b32 v125, v125, v6, vcc
  v_cmp_le_i32 vcc, 2, v5
  s_nop 1
  v_cndmask_b32 v242, v6, v242, vcc
  v_cndmask_b32 v114, v114, v6, vcc
  v_cndmask_b32 v254, v6, v254, vcc
  v_cndmask_b32 v126, v126, v6, vcc
  v_cmp_le_i32 vcc, 3, v5
  s_nop 1
  v_cndmask_b32 v243, v6, v243, vcc
  v_cndmask_b32 v115, v115, v6, vcc
  v_cndmask_b32 v255, v6, v255, vcc
  v_cndmask_b32 v127, v127, v6, vcc
  v_mov_b32 v248, v6
  v_mov_b32 v116, v6
  v_mov_b32 v249, v6
  v_mov_b32 v117, v6
  v_mov_b32 v250, v6
  v_mov_b32 v118, v6
  v_mov_b32 v251, v6
  v_mov_b32 v119, v6
  s_cmp_lg_u32 s52, 0
  s_nop 0
  s_cbranch_scc1 L_b0_29
  s_add_u32 s44, s54, 0
  s_cmp_ge_u32 s44, 8
  s_cbranch_scc1 L_b0_29
  v_mov_b32 v112, v6
  v_mov_b32 v113, v6
  v_mov_b32 v114, v6
  v_mov_b32 v115, v6
  v_mov_b32 v116, v6
  v_mov_b32 v117, v6
  v_mov_b32 v118, v6
  v_mov_b32 v119, v6
  v_mov_b32 v120, v6
  v_mov_b32 v121, v6
  v_mov_b32 v122, v6
  v_mov_b32 v123, v6
  v_mov_b32 v124, v6
  v_mov_b32 v125, v6
  v_mov_b32 v126, v6
  v_mov_b32 v127, v6
  s_add_u32 s44, s54, 1
  s_cmp_ge_u32 s44, 8
  s_cbranch_scc1 L_b0_29
  v_mov_b32 v128, v6
  v_mov_b32 v129, v6
  v_mov_b32 v130, v6
  v_mov_b32 v131, v6
  v_mov_b32 v132, v6
  v_mov_b32 v133, v6
  v_mov_b32 v134, v6
  v_mov_b32 v135, v6
  v_mov_b32 v136, v6
  v_mov_b32 v137, v6
  v_mov_b32 v138, v6
  v_mov_b32 v139, v6
  v_mov_b32 v140, v6
  v_mov_b32 v141, v6
  v_mov_b32 v142, v6
  v_mov_b32 v143, v6
  s_add_u32 s44, s54, 2
  s_cmp_ge_u32 s44, 8
  s_cbranch_scc1 L_b0_29
  v_mov_b32 v144, v6
  v_mov_b32 v145, v6
  v_mov_b32 v146, v6
  v_mov_b32 v147, v6
  v_mov_b32 v148, v6
  v_mov_b32 v149, v6
  v_mov_b32 v150, v6
  v_mov_b32 v151, v6
  v_mov_b32 v152, v6
  v_mov_b32 v153, v6
  v_mov_b32 v154, v6
  v_mov_b32 v155, v6
  v_mov_b32 v156, v6
  v_mov_b32 v157, v6
  v_mov_b32 v158, v6
  v_mov_b32 v159, v6
  s_add_u32 s44, s54, 3
  s_cmp_ge_u32 s44, 8
  s_cbranch_scc1 L_b0_29
  v_mov_b32 v160, v6
  v_mov_b32 v161, v6
  v_mov_b32 v162, v6
  v_mov_b32 v163, v6
  v_mov_b32 v164, v6
  v_mov_b32 v165, v6
  v_mov_b32 v166, v6
  v_mov_b32 v167, v6
  v_mov_b32 v168, v6
  v_mov_b32 v169, v6
  v_mov_b32 v170, v6
  v_mov_b32 v171, v6
  v_mov_b32 v172, v6
  v_mov_b32 v173, v6
  v_mov_b32 v174, v6
  v_mov_b32 v175, v6
  s_add_u32 s44, s54, 4
  s_cmp_ge_u32 s44, 8
  s_cbranch_scc1 L_b0_29
  v_mov_b32 v176, v6
  v_mov_b32 v177, v6
  v_mov_b32 v178, v6
  v_mov_b32 v179, v6
  v_mov_b32 v180, v6
  v_mov_b32 v181, v6
  v_mov_b32 v182, v6
  v_mov_b32 v183, v6
  v_mov_b32 v184, v6
  v_mov_b32 v185, v6
  v_mov_b32 v186, v6
  v_mov_b32 v187, v6
  v_mov_b32 v188, v6
  v_mov_b32 v189, v6
  v_mov_b32 v190, v6
  v_mov_b32 v191, v6
  s_add_u32 s44, s54, 5
  s_cmp_ge_u32 s44, 8
  s_cbranch_scc1 L_b0_29
  v_mov_b32 v192, v6
  v_mov_b32 v193, v6
  v_mov_b32 v194, v6
  v_mov_b32 v195, v6
  v_mov_b32 v196, v6
  v_mov_b32 v197, v6
  v_mov_b32 v198, v6
  v_mov_b32 v199, v6
  v_mov_b32 v200, v6
  v_mov_b32 v201, v6
  v_mov_b32 v202, v6
  v_mov_b32 v203, v6
  v_mov_b32 v204, v6
  v_mov_b32 v205, v6
  v_mov_b32 v206, v6
  v_mov_b32 v207, v6
  s_add_u32 s44, s54, 6
  s_cmp_ge_u32 s44, 8
  s_cbranch_scc1 L_b0_29
  v_mov_b32 v208, v6
  v_mov_b32 v209, v6
  v_mov_b32 v210, v6
  v_mov_b32 v211, v6
  v_mov_b32 v212, v6
  v_mov_b32 v213, v6
  v_mov_b32 v214, v6
  v_mov_b32 v215, v6
  v_mov_b32 v216, v6
  v_mov_b32 v217, v6
  v_mov_b32 v218, v6
  v_mov_b32 v219, v6
  v_mov_b32 v220, v6
  v_mov_b32 v221, v6
  v_mov_b32 v222, v6
  v_mov_b32 v223, v6
  s_add_u32 s44, s54, 7
  s_cmp_ge_u32 s44, 8
  s_cbranch_scc1 L_b0_29
  v_mov_b32 v224, v6
  v_mov_b32 v225, v6
  v_mov_b32 v226, v6
  v_mov_b32 v227, v6
  v_mov_b32 v228, v6
  v_mov_b32 v229, v6
  v_mov_b32 v230, v6
  v_mov_b32 v231, v6
  v_mov_b32 v232, v6
  v_mov_b32 v233, v6
  v_mov_b32 v234, v6
  v_mov_b32 v235, v6
  v_mov_b32 v236, v6
  v_mov_b32 v237, v6
  v_mov_b32 v238, v6
  v_mov_b32 v239, v6
  s_nop 1
L_b0_29:
  v_max3_f32 v40, v112, v113, v114
  v_max3_f32 v40, v40, v115, v120
  v_max3_f32 v40, v40, v121, v122
  v_max3_f32 v40, v40, v123, v128
  v_max3_f32 v40, v40, v129, v130
  v_max3_f32 v40, v40, v131, v136
  v_max3_f32 v40, v40, v137, v138
  v_max3_f32 v40, v40, v139, v144
  v_max3_f32 v40, v40, v145, v146
  v_max3_f32 v40, v40, v147, v152
  v_max3_f32 v40, v40, v153, v154
  v_max3_f32 v40, v40, v155, v160
  v_max3_f32 v40, v40, v161, v162
  v_max3_f32 v40, v40, v163, v168
  v_max3_f32 v40, v40, v169, v170
  v_max3_f32 v40, v40, v171, v176
  v_max3_f32 v40, v40, v177, v178
  v_max3_f32 v40, v40, v179, v184
  v_max3_f32 v40, v40, v185, v186
  v_max3_f32 v40, v40, v187, v192
  v_max3_f32 v40, v40, v193, v194
  v_max3_f32 v40, v40, v195, v200
  v_max3_f32 v40, v40, v201, v202
  v_max3_f32 v40, v40, v203, v208
  v_max3_f32 v40, v40, v209, v210
  v_max3_f32 v40, v40, v211, v216
  v_max3_f32 v40, v40, v217, v218
  v_max3_f32 v40, v40, v219, v224
  v_max3_f32 v40, v40, v225, v226
  v_max3_f32 v40, v40, v227, v232
  v_max3_f32 v40, v40, v233, v234
  v_max3_f32 v40, v40, v235, v240
  v_max3_f32 v40, v40, v241, v242
  v_max3_f32 v40, v40, v243, v248
  v_max3_f32 v40, v40, v249, v250
  v_max_f32 v40, v40, v251
  v_max3_f32 v41, v116, v117, v118
  v_max3_f32 v41, v41, v119, v124
  v_max3_f32 v41, v41, v125, v126
  v_max3_f32 v41, v41, v127, v132
  v_max3_f32 v41, v41, v133, v134
  v_max3_f32 v41, v41, v135, v140
  v_max3_f32 v41, v41, v141, v142
  v_max3_f32 v41, v41, v143, v148
  v_max3_f32 v41, v41, v149, v150
  v_max3_f32 v41, v41, v151, v156
  v_max3_f32 v41, v41, v157, v158
  v_max3_f32 v41, v41, v159, v164
  v_max3_f32 v41, v41, v165, v166
  v_max3_f32 v41, v41, v167, v172
  v_max3_f32 v41, v41, v173, v174
  v_max3_f32 v41, v41, v175, v180
  v_max3_f32 v41, v41, v181, v182
  v_max3_f32 v41, v41, v183, v188
  v_max3_f32 v41, v41, v189, v190
  v_max3_f32 v41, v41, v191, v196
  v_max3_f32 v41, v41, v197, v198
  v_max3_f32 v41, v41, v199, v204
  v_max3_f32 v41, v41, v205, v206
  v_max3_f32 v41, v41, v207, v212
  v_max3_f32 v41, v41, v213, v214
  v_max3_f32 v41, v41, v215, v220
  v_max3_f32 v41, v41, v221, v222
  v_max3_f32 v41, v41, v223, v228
  v_max3_f32 v41, v41, v229, v230
  v_max3_f32 v41, v41, v231, v236
  v_max3_f32 v41, v41, v237, v238
  v_max3_f32 v41, v41, v239, v244
  v_max3_f32 v41, v41, v245, v246
  v_max3_f32 v41, v41, v247, v252
  v_max3_f32 v41, v41, v253, v254
  v_max_f32 v41, v41, v255
  v_mov_b32 v42, v40
  s_nop 1
  v_permlane16_swap_b32 v40, v42
  v_max_f32 v40, v40, v42
  v_mov_b32 v42, v40
  s_nop 1
  v_permlane32_swap_b32 v40, v42
  v_max_f32 v40, v40, v42
  v_mov_b32 v42, v41
  s_nop 1
  v_permlane16_swap_b32 v41, v42
  v_max_f32 v41, v41, v42
  v_mov_b32 v42, v41
  s_nop 1
  v_permlane32_swap_b32 v41, v42
  v_max_f32 v41, v41, v42
  s_mov_b32 s44, 0x3ea52b5c
  v_mul_f32 v40, s44, v40
  v_mul_f32 v41, s44, v41
  v_bfe_u32 v3, v1, 2, 2
  v_and_b32 v4, 3, v1
  v_lshl_add_u32 v5, v2, 2, v3
  v_lshlrev_b32 v5, 6, v5
  v_lshl_add_u32 v5, v4, 3, v5
  v_add_u32 v5, s45, v5
  v_add_u32 v5, 114688, v5
  v_and_b32 v8, 1, v2
  v_lshl_add_u32 v9, v8, 5, v5
  v_xor_b32 v8, 1, v8
  v_lshl_add_u32 v10, v8, 5, v5
  v_mov_b32 v16, 0
  v_mov_b32 v17, 0
  v_mov_b32 v18, 0
  v_mov_b32 v19, 0
  v_mov_b32 v20, 0
  v_mov_b32 v21, 0
  v_mov_b32 v22, 0
  v_mov_b32 v23, 0
  v_mov_b32 v24, 0
  v_mov_b32 v25, 0
  v_mov_b32 v26, 0
  v_mov_b32 v27, 0
  v_mov_b32 v28, 0
  v_mov_b32 v29, 0
  v_mov_b32 v30, 0
  v_mov_b32 v31, 0
  ds_read_b64_tr_b16 v[80:81], v9 offset:0
  ds_read_b64_tr_b16 v[82:83], v9 offset:1024
  ds_read_b64_tr_b16 v[84:85], v10 offset:0
  ds_read_b64_tr_b16 v[86:87], v10 offset:1024
  ds_read_b64_tr_b16 v[88:89], v9 offset:2048
  ds_read_b64_tr_b16 v[90:91], v9 offset:3072
  ds_read_b64_tr_b16 v[92:93], v10 offset:2048
  ds_read_b64_tr_b16 v[94:95], v10 offset:3072
  s_add_u32 s45, s71, 0
  s_add_u32 m0, s70, 0
  s_nop 0
  buffer_load_dwordx4 v96, s[28:31], s45 offen lds
  v_fma_f32 v112, v112, s44, -v40
  v_fma_f32 v113, v113, s44, -v40
  v_fma_f32 v114, v114, s44, -v40
  v_fma_f32 v115, v115, s44, -v40
  v_fma_f32 v120, v120, s44, -v40
  v_fma_f32 v121, v121, s44, -v40
  v_fma_f32 v122, v122, s44, -v40
  v_fma_f32 v123, v123, s44, -v40
  v_exp_f32 v112, v112
  v_exp_f32 v113, v113
  v_exp_f32 v114, v114
  v_exp_f32 v115, v115
  v_exp_f32 v120, v120
  v_exp_f32 v121, v121
  v_exp_f32 v122, v122
  v_exp_f32 v123, v123
  v_cvt_pk_bf16_f32 v48, v112, v113
  v_cvt_pk_bf16_f32 v49, v114, v115
  v_cvt_pk_bf16_f32 v50, v120, v121
  v_cvt_pk_bf16_f32 v51, v122, v123
  v_fma_f32 v116, v116, s44, -v41
  v_fma_f32 v117, v117, s44, -v41
  v_fma_f32 v118, v118, s44, -v41
  v_fma_f32 v119, v119, s44, -v41
  v_fma_f32 v124, v124, s44, -v41
  v_fma_f32 v125, v125, s44, -v41
  v_fma_f32 v126, v126, s44, -v41
  v_fma_f32 v127, v127, s44, -v41
  v_exp_f32 v116, v116
  v_exp_f32 v117, v117
  v_exp_f32 v118, v118
  v_exp_f32 v119, v119
  v_exp_f32 v124, v124
  v_exp_f32 v125, v125
  v_exp_f32 v126, v126
  v_exp_f32 v127, v127
  v_cvt_pk_bf16_f32 v52, v116, v117
  v_cvt_pk_bf16_f32 v53, v118, v119
  v_cvt_pk_bf16_f32 v54, v124, v125
  v_cvt_pk_bf16_f32 v55, v126, v127
  s_waitcnt lgkmcnt(4)
  v_mfma_f32_16x16x32_bf16 v[16:19], v[80:83], v[48:51], v[16:19]
  v_mfma_f32_16x16x32_bf16 v[20:23], v[84:87], v[48:51], v[20:23]
  v_mfma_f32_16x16x32_bf16 v[24:27], v[80:83], v[52:55], v[24:27]
  v_mfma_f32_16x16x32_bf16 v[28:31], v[84:87], v[52:55], v[28:31]
  s_nop 1
  ds_read_b64_tr_b16 v[80:81], v9 offset:4096
  ds_read_b64_tr_b16 v[82:83], v9 offset:5120
  ds_read_b64_tr_b16 v[84:85], v10 offset:4096
  ds_read_b64_tr_b16 v[86:87], v10 offset:5120
  s_add_u32 s45, s71, 0
  s_add_u32 m0, s70, 1024
  s_nop 0
  buffer_load_dwordx4 v97, s[28:31], s45 offen lds
  v_fma_f32 v128, v128, s44, -v40
  v_fma_f32 v129, v129, s44, -v40
  v_fma_f32 v130, v130, s44, -v40
  v_fma_f32 v131, v131, s44, -v40
  v_fma_f32 v136, v136, s44, -v40
  v_fma_f32 v137, v137, s44, -v40
  v_fma_f32 v138, v138, s44, -v40
  v_fma_f32 v139, v139, s44, -v40
  v_exp_f32 v128, v128
  v_exp_f32 v129, v129
  v_exp_f32 v130, v130
  v_exp_f32 v131, v131
  v_exp_f32 v136, v136
  v_exp_f32 v137, v137
  v_exp_f32 v138, v138
  v_exp_f32 v139, v139
  v_cvt_pk_bf16_f32 v48, v128, v129
  v_cvt_pk_bf16_f32 v49, v130, v131
  v_cvt_pk_bf16_f32 v50, v136, v137
  v_cvt_pk_bf16_f32 v51, v138, v139
  v_fma_f32 v132, v132, s44, -v41
  v_fma_f32 v133, v133, s44, -v41
  v_fma_f32 v134, v134, s44, -v41
  v_fma_f32 v135, v135, s44, -v41
  v_fma_f32 v140, v140, s44, -v41
  v_fma_f32 v141, v141, s44, -v41
  v_fma_f32 v142, v142, s44, -v41
  v_fma_f32 v143, v143, s44, -v41
  v_exp_f32 v132, v132
  v_exp_f32 v133, v133
  v_exp_f32 v134, v134
  v_exp_f32 v135, v135
  v_exp_f32 v140, v140
  v_exp_f32 v141, v141
  v_exp_f32 v142, v142
  v_exp_f32 v143, v143
  v_cvt_pk_bf16_f32 v52, v132, v133
  v_cvt_pk_bf16_f32 v53, v134, v135
  v_cvt_pk_bf16_f32 v54, v140, v141
  v_cvt_pk_bf16_f32 v55, v142, v143
  s_waitcnt lgkmcnt(4)
  v_mfma_f32_16x16x32_bf16 v[16:19], v[88:91], v[48:51], v[16:19]
  v_mfma_f32_16x16x32_bf16 v[20:23], v[92:95], v[48:51], v[20:23]
  v_mfma_f32_16x16x32_bf16 v[24:27], v[88:91], v[52:55], v[24:27]
  v_mfma_f32_16x16x32_bf16 v[28:31], v[92:95], v[52:55], v[28:31]
  s_nop 1
  ds_read_b64_tr_b16 v[88:89], v9 offset:6144
  ds_read_b64_tr_b16 v[90:91], v9 offset:7168
  ds_read_b64_tr_b16 v[92:93], v10 offset:6144
  ds_read_b64_tr_b16 v[94:95], v10 offset:7168
  s_add_u32 s45, s71, 0
  s_add_u32 m0, s70, 2048
  s_mov_b64 exec, s[64:65]
  buffer_load_dwordx4 v98, s[28:31], s45 offen lds
  s_mov_b64 exec, -1
  v_fma_f32 v144, v144, s44, -v40
  v_fma_f32 v145, v145, s44, -v40
  v_fma_f32 v146, v146, s44, -v40
  v_fma_f32 v147, v147, s44, -v40
  v_fma_f32 v152, v152, s44, -v40
  v_fma_f32 v153, v153, s44, -v40
  v_fma_f32 v154, v154, s44, -v40
  v_fma_f32 v155, v155, s44, -v40
  v_exp_f32 v144, v144
  v_exp_f32 v145, v145
  v_exp_f32 v146, v146
  v_exp_f32 v147, v147
  v_exp_f32 v152, v152
  v_exp_f32 v153, v153
  v_exp_f32 v154, v154
  v_exp_f32 v155, v155
  v_cvt_pk_bf16_f32 v48, v144, v145
  v_cvt_pk_bf16_f32 v49, v146, v147
  v_cvt_pk_bf16_f32 v50, v152, v153
  v_cvt_pk_bf16_f32 v51, v154, v155
  v_fma_f32 v148, v148, s44, -v41
  v_fma_f32 v149, v149, s44, -v41
  v_fma_f32 v150, v150, s44, -v41
  v_fma_f32 v151, v151, s44, -v41
  v_fma_f32 v156, v156, s44, -v41
  v_fma_f32 v157, v157, s44, -v41
  v_fma_f32 v158, v158, s44, -v41
  v_fma_f32 v159, v159, s44, -v41
  v_exp_f32 v148, v148
  v_exp_f32 v149, v149
  v_exp_f32 v150, v150
  v_exp_f32 v151, v151
  v_exp_f32 v156, v156
  v_exp_f32 v157, v157
  v_exp_f32 v158, v158
  v_exp_f32 v159, v159
  v_cvt_pk_bf16_f32 v52, v148, v149
  v_cvt_pk_bf16_f32 v53, v150, v151
  v_cvt_pk_bf16_f32 v54, v156, v157
  v_cvt_pk_bf16_f32 v55, v158, v159
  s_waitcnt lgkmcnt(4)
  v_mfma_f32_16x16x32_bf16 v[16:19], v[80:83], v[48:51], v[16:19]
  v_mfma_f32_16x16x32_bf16 v[20:23], v[84:87], v[48:51], v[20:23]
  v_mfma_f32_16x16x32_bf16 v[24:27], v[80:83], v[52:55], v[24:27]
  v_mfma_f32_16x16x32_bf16 v[28:31], v[84:87], v[52:55], v[28:31]
  s_nop 1
  ds_read_b64_tr_b16 v[80:81], v9 offset:8192
  ds_read_b64_tr_b16 v[82:83], v9 offset:9216
  ds_read_b64_tr_b16 v[84:85], v10 offset:8192
  ds_read_b64_tr_b16 v[86:87], v10 offset:9216
  s_add_u32 s45, s71, 0
  s_add_u32 m0, s70, 5632
  s_nop 0
  buffer_load_dwordx4 v99, s[28:31], s45 offen lds
  v_fma_f32 v160, v160, s44, -v40
  v_fma_f32 v161, v161, s44, -v40
  v_fma_f32 v162, v162, s44, -v40
  v_fma_f32 v163, v163, s44, -v40
  v_fma_f32 v168, v168, s44, -v40
  v_fma_f32 v169, v169, s44, -v40
  v_fma_f32 v170, v170, s44, -v40
  v_fma_f32 v171, v171, s44, -v40
  v_exp_f32 v160, v160
  v_exp_f32 v161, v161
  v_exp_f32 v162, v162
  v_exp_f32 v163, v163
  v_exp_f32 v168, v168
  v_exp_f32 v169, v169
  v_exp_f32 v170, v170
  v_exp_f32 v171, v171
  v_cvt_pk_bf16_f32 v48, v160, v161
  v_cvt_pk_bf16_f32 v49, v162, v163
  v_cvt_pk_bf16_f32 v50, v168, v169
  v_cvt_pk_bf16_f32 v51, v170, v171
  v_fma_f32 v164, v164, s44, -v41
  v_fma_f32 v165, v165, s44, -v41
  v_fma_f32 v166, v166, s44, -v41
  v_fma_f32 v167, v167, s44, -v41
  v_fma_f32 v172, v172, s44, -v41
  v_fma_f32 v173, v173, s44, -v41
  v_fma_f32 v174, v174, s44, -v41
  v_fma_f32 v175, v175, s44, -v41
  v_exp_f32 v164, v164
  v_exp_f32 v165, v165
  v_exp_f32 v166, v166
  v_exp_f32 v167, v167
  v_exp_f32 v172, v172
  v_exp_f32 v173, v173
  v_exp_f32 v174, v174
  v_exp_f32 v175, v175
  v_cvt_pk_bf16_f32 v52, v164, v165
  v_cvt_pk_bf16_f32 v53, v166, v167
  v_cvt_pk_bf16_f32 v54, v172, v173
  v_cvt_pk_bf16_f32 v55, v174, v175
  s_waitcnt lgkmcnt(4)
  v_mfma_f32_16x16x32_bf16 v[16:19], v[88:91], v[48:51], v[16:19]
  v_mfma_f32_16x16x32_bf16 v[20:23], v[92:95], v[48:51], v[20:23]
  v_mfma_f32_16x16x32_bf16 v[24:27], v[88:91], v[52:55], v[24:27]
  v_mfma_f32_16x16x32_bf16 v[28:31], v[92:95], v[52:55], v[28:31]
  s_nop 1
  ds_read_b64_tr_b16 v[88:89], v9 offset:10240
  ds_read_b64_tr_b16 v[90:91], v9 offset:11264
  ds_read_b64_tr_b16 v[92:93], v10 offset:10240
  ds_read_b64_tr_b16 v[94:95], v10 offset:11264
  s_add_u32 s45, s71, 0
  s_add_u32 m0, s70, 6656
  s_nop 0
  buffer_load_dwordx4 v100, s[28:31], s45 offen lds
  v_fma_f32 v176, v176, s44, -v40
  v_fma_f32 v177, v177, s44, -v40
  v_fma_f32 v178, v178, s44, -v40
  v_fma_f32 v179, v179, s44, -v40
  v_fma_f32 v184, v184, s44, -v40
  v_fma_f32 v185, v185, s44, -v40
  v_fma_f32 v186, v186, s44, -v40
  v_fma_f32 v187, v187, s44, -v40
  v_exp_f32 v176, v176
  v_exp_f32 v177, v177
  v_exp_f32 v178, v178
  v_exp_f32 v179, v179
  v_exp_f32 v184, v184
  v_exp_f32 v185, v185
  v_exp_f32 v186, v186
  v_exp_f32 v187, v187
  v_cvt_pk_bf16_f32 v48, v176, v177
  v_cvt_pk_bf16_f32 v49, v178, v179
  v_cvt_pk_bf16_f32 v50, v184, v185
  v_cvt_pk_bf16_f32 v51, v186, v187
  v_fma_f32 v180, v180, s44, -v41
  v_fma_f32 v181, v181, s44, -v41
  v_fma_f32 v182, v182, s44, -v41
  v_fma_f32 v183, v183, s44, -v41
  v_fma_f32 v188, v188, s44, -v41
  v_fma_f32 v189, v189, s44, -v41
  v_fma_f32 v190, v190, s44, -v41
  v_fma_f32 v191, v191, s44, -v41
  v_exp_f32 v180, v180
  v_exp_f32 v181, v181
  v_exp_f32 v182, v182
  v_exp_f32 v183, v183
  v_exp_f32 v188, v188
  v_exp_f32 v189, v189
  v_exp_f32 v190, v190
  v_exp_f32 v191, v191
  v_cvt_pk_bf16_f32 v52, v180, v181
  v_cvt_pk_bf16_f32 v53, v182, v183
  v_cvt_pk_bf16_f32 v54, v188, v189
  v_cvt_pk_bf16_f32 v55, v190, v191
  s_waitcnt lgkmcnt(4)
  v_mfma_f32_16x16x32_bf16 v[16:19], v[80:83], v[48:51], v[16:19]
  v_mfma_f32_16x16x32_bf16 v[20:23], v[84:87], v[48:51], v[20:23]
  v_mfma_f32_16x16x32_bf16 v[24:27], v[80:83], v[52:55], v[24:27]
  v_mfma_f32_16x16x32_bf16 v[28:31], v[84:87], v[52:55], v[28:31]
  s_nop 1
  ds_read_b64_tr_b16 v[80:81], v9 offset:12288
  ds_read_b64_tr_b16 v[82:83], v9 offset:13312
  ds_read_b64_tr_b16 v[84:85], v10 offset:12288
  ds_read_b64_tr_b16 v[86:87], v10 offset:13312
  s_add_u32 s45, s71, 0
  s_add_u32 m0, s70, 7680
  s_mov_b64 exec, s[64:65]
  buffer_load_dwordx4 v101, s[28:31], s45 offen lds
  s_mov_b64 exec, -1
  v_fma_f32 v192, v192, s44, -v40
  v_fma_f32 v193, v193, s44, -v40
  v_fma_f32 v194, v194, s44, -v40
  v_fma_f32 v195, v195, s44, -v40
  v_fma_f32 v200, v200, s44, -v40
  v_fma_f32 v201, v201, s44, -v40
  v_fma_f32 v202, v202, s44, -v40
  v_fma_f32 v203, v203, s44, -v40
  v_exp_f32 v192, v192
  v_exp_f32 v193, v193
  v_exp_f32 v194, v194
  v_exp_f32 v195, v195
  v_exp_f32 v200, v200
  v_exp_f32 v201, v201
  v_exp_f32 v202, v202
  v_exp_f32 v203, v203
  v_cvt_pk_bf16_f32 v48, v192, v193
  v_cvt_pk_bf16_f32 v49, v194, v195
  v_cvt_pk_bf16_f32 v50, v200, v201
  v_cvt_pk_bf16_f32 v51, v202, v203
  v_fma_f32 v196, v196, s44, -v41
  v_fma_f32 v197, v197, s44, -v41
  v_fma_f32 v198, v198, s44, -v41
  v_fma_f32 v199, v199, s44, -v41
  v_fma_f32 v204, v204, s44, -v41
  v_fma_f32 v205, v205, s44, -v41
  v_fma_f32 v206, v206, s44, -v41
  v_fma_f32 v207, v207, s44, -v41
  v_exp_f32 v196, v196
  v_exp_f32 v197, v197
  v_exp_f32 v198, v198
  v_exp_f32 v199, v199
  v_exp_f32 v204, v204
  v_exp_f32 v205, v205
  v_exp_f32 v206, v206
  v_exp_f32 v207, v207
  v_cvt_pk_bf16_f32 v52, v196, v197
  v_cvt_pk_bf16_f32 v53, v198, v199
  v_cvt_pk_bf16_f32 v54, v204, v205
  v_cvt_pk_bf16_f32 v55, v206, v207
  s_waitcnt lgkmcnt(4)
  v_mfma_f32_16x16x32_bf16 v[16:19], v[88:91], v[48:51], v[16:19]
  v_mfma_f32_16x16x32_bf16 v[20:23], v[92:95], v[48:51], v[20:23]
  v_mfma_f32_16x16x32_bf16 v[24:27], v[88:91], v[52:55], v[24:27]
  v_mfma_f32_16x16x32_bf16 v[28:31], v[92:95], v[52:55], v[28:31]
  s_nop 1
  ds_read_b64_tr_b16 v[88:89], v9 offset:14336
  ds_read_b64_tr_b16 v[90:91], v9 offset:15360
  ds_read_b64_tr_b16 v[92:93], v10 offset:14336
  ds_read_b64_tr_b16 v[94:95], v10 offset:15360
  s_add_u32 s45, s71, 0
  s_add_u32 m0, s70, 11264
  s_nop 0
  buffer_load_dwordx4 v102, s[28:31], s45 offen lds
  v_fma_f32 v208, v208, s44, -v40
  v_fma_f32 v209, v209, s44, -v40
  v_fma_f32 v210, v210, s44, -v40
  v_fma_f32 v211, v211, s44, -v40
  v_fma_f32 v216, v216, s44, -v40
  v_fma_f32 v217, v217, s44, -v40
  v_fma_f32 v218, v218, s44, -v40
  v_fma_f32 v219, v219, s44, -v40
  v_exp_f32 v208, v208
  v_exp_f32 v209, v209
  v_exp_f32 v210, v210
  v_exp_f32 v211, v211
  v_exp_f32 v216, v216
  v_exp_f32 v217, v217
  v_exp_f32 v218, v218
  v_exp_f32 v219, v219
  v_cvt_pk_bf16_f32 v48, v208, v209
  v_cvt_pk_bf16_f32 v49, v210, v211
  v_cvt_pk_bf16_f32 v50, v216, v217
  v_cvt_pk_bf16_f32 v51, v218, v219
  v_fma_f32 v212, v212, s44, -v41
  v_fma_f32 v213, v213, s44, -v41
  v_fma_f32 v214, v214, s44, -v41
  v_fma_f32 v215, v215, s44, -v41
  v_fma_f32 v220, v220, s44, -v41
  v_fma_f32 v221, v221, s44, -v41
  v_fma_f32 v222, v222, s44, -v41
  v_fma_f32 v223, v223, s44, -v41
  v_exp_f32 v212, v212
  v_exp_f32 v213, v213
  v_exp_f32 v214, v214
  v_exp_f32 v215, v215
  v_exp_f32 v220, v220
  v_exp_f32 v221, v221
  v_exp_f32 v222, v222
  v_exp_f32 v223, v223
  v_cvt_pk_bf16_f32 v52, v212, v213
  v_cvt_pk_bf16_f32 v53, v214, v215
  v_cvt_pk_bf16_f32 v54, v220, v221
  v_cvt_pk_bf16_f32 v55, v222, v223
  s_waitcnt lgkmcnt(4)
  v_mfma_f32_16x16x32_bf16 v[16:19], v[80:83], v[48:51], v[16:19]
  v_mfma_f32_16x16x32_bf16 v[20:23], v[84:87], v[48:51], v[20:23]
  v_mfma_f32_16x16x32_bf16 v[24:27], v[80:83], v[52:55], v[24:27]
  v_mfma_f32_16x16x32_bf16 v[28:31], v[84:87], v[52:55], v[28:31]
  s_nop 1
  ds_read_b64_tr_b16 v[80:81], v9 offset:16384
  ds_read_b64_tr_b16 v[82:83], v9 offset:17408
  ds_read_b64_tr_b16 v[84:85], v10 offset:16384
  ds_read_b64_tr_b16 v[86:87], v10 offset:17408
  s_add_u32 s45, s71, 0
  s_add_u32 m0, s70, 12288
  s_nop 0
  buffer_load_dwordx4 v103, s[28:31], s45 offen lds
  v_fma_f32 v224, v224, s44, -v40
  v_fma_f32 v225, v225, s44, -v40
  v_fma_f32 v226, v226, s44, -v40
  v_fma_f32 v227, v227, s44, -v40
  v_fma_f32 v232, v232, s44, -v40
  v_fma_f32 v233, v233, s44, -v40
  v_fma_f32 v234, v234, s44, -v40
  v_fma_f32 v235, v235, s44, -v40
  v_exp_f32 v224, v224
  v_exp_f32 v225, v225
  v_exp_f32 v226, v226
  v_exp_f32 v227, v227
  v_exp_f32 v232, v232
  v_exp_f32 v233, v233
  v_exp_f32 v234, v234
  v_exp_f32 v235, v235
  v_cvt_pk_bf16_f32 v48, v224, v225
  v_cvt_pk_bf16_f32 v49, v226, v227
  v_cvt_pk_bf16_f32 v50, v232, v233
  v_cvt_pk_bf16_f32 v51, v234, v235
  v_fma_f32 v228, v228, s44, -v41
  v_fma_f32 v229, v229, s44, -v41
  v_fma_f32 v230, v230, s44, -v41
  v_fma_f32 v231, v231, s44, -v41
  v_fma_f32 v236, v236, s44, -v41
  v_fma_f32 v237, v237, s44, -v41
  v_fma_f32 v238, v238, s44, -v41
  v_fma_f32 v239, v239, s44, -v41
  v_exp_f32 v228, v228
  v_exp_f32 v229, v229
  v_exp_f32 v230, v230
  v_exp_f32 v231, v231
  v_exp_f32 v236, v236
  v_exp_f32 v237, v237
  v_exp_f32 v238, v238
  v_exp_f32 v239, v239
  v_cvt_pk_bf16_f32 v52, v228, v229
  v_cvt_pk_bf16_f32 v53, v230, v231
  v_cvt_pk_bf16_f32 v54, v236, v237
  v_cvt_pk_bf16_f32 v55, v238, v239
  s_waitcnt lgkmcnt(4)
  v_mfma_f32_16x16x32_bf16 v[16:19], v[88:91], v[48:51], v[16:19]
  v_mfma_f32_16x16x32_bf16 v[20:23], v[92:95], v[48:51], v[20:23]
  v_mfma_f32_16x16x32_bf16 v[24:27], v[88:91], v[52:55], v[24:27]
  v_mfma_f32_16x16x32_bf16 v[28:31], v[92:95], v[52:55], v[28:31]
  s_add_u32 s45, s71, 0
  s_add_u32 m0, s70, 13312
  s_mov_b64 exec, s[64:65]
  buffer_load_dwordx4 v104, s[28:31], s45 offen lds
  s_mov_b64 exec, -1
  v_fma_f32 v240, v240, s44, -v40
  v_fma_f32 v241, v241, s44, -v40
  v_fma_f32 v242, v242, s44, -v40
  v_fma_f32 v243, v243, s44, -v40
  v_fma_f32 v248, v248, s44, -v40
  v_fma_f32 v249, v249, s44, -v40
  v_fma_f32 v250, v250, s44, -v40
  v_fma_f32 v251, v251, s44, -v40
  v_exp_f32 v240, v240
  v_exp_f32 v241, v241
  v_exp_f32 v242, v242
  v_exp_f32 v243, v243
  v_exp_f32 v248, v248
  v_exp_f32 v249, v249
  v_exp_f32 v250, v250
  v_exp_f32 v251, v251
  v_cvt_pk_bf16_f32 v48, v240, v241
  v_cvt_pk_bf16_f32 v49, v242, v243
  v_cvt_pk_bf16_f32 v50, v248, v249
  v_cvt_pk_bf16_f32 v51, v250, v251
  v_fma_f32 v244, v244, s44, -v41
  v_fma_f32 v245, v245, s44, -v41
  v_fma_f32 v246, v246, s44, -v41
  v_fma_f32 v247, v247, s44, -v41
  v_fma_f32 v252, v252, s44, -v41
  v_fma_f32 v253, v253, s44, -v41
  v_fma_f32 v254, v254, s44, -v41
  v_fma_f32 v255, v255, s44, -v41
  v_exp_f32 v244, v244
  v_exp_f32 v245, v245
  v_exp_f32 v246, v246
  v_exp_f32 v247, v247
  v_exp_f32 v252, v252
  v_exp_f32 v253, v253
  v_exp_f32 v254, v254
  v_exp_f32 v255, v255
  v_cvt_pk_bf16_f32 v52, v244, v245
  v_cvt_pk_bf16_f32 v53, v246, v247
  v_cvt_pk_bf16_f32 v54, v252, v253
  v_cvt_pk_bf16_f32 v55, v254, v255
  s_waitcnt lgkmcnt(0)
  v_mfma_f32_16x16x32_bf16 v[16:19], v[80:83], v[48:51], v[16:19]
  v_mfma_f32_16x16x32_bf16 v[20:23], v[84:87], v[48:51], v[20:23]
  v_mfma_f32_16x16x32_bf16 v[24:27], v[80:83], v[52:55], v[24:27]
  v_mfma_f32_16x16x32_bf16 v[28:31], v[84:87], v[52:55], v[28:31]
  v_lshrrev_b32 v132, 4, v1
  v_bfe_u32 v133, v1, 2, 2
  v_and_b32 v134, 3, v1
  v_mul_u32_u24 v132, 1408, v132
  v_mul_u32_u24 v133, 160, v133
  v_add_u32 v132, v132, v133
  v_lshl_add_u32 v132, v134, 3, v132
  v_lshlrev_b32 v133, 4, v1
  s_cmp_eq_u32 s74, 0
  s_nop 0
  s_cbranch_scc1 L_nojobf_38
  s_sub_u32 s46, s43, 4
  s_mul_i32 s46, s46, 5632
  s_add_u32 s46, s46, 67584
  v_add_u32 v132, s46, v132
  s_waitcnt vmcnt(9)
  ds_read_b64_tr_b16 v[112:113], v132 offset:0
  ds_read_b64_tr_b16 v[114:115], v132 offset:640
  ds_read_b64_tr_b16 v[116:117], v132 offset:32
  ds_read_b64_tr_b16 v[118:119], v132 offset:672
  ds_read_b64_tr_b16 v[120:121], v132 offset:64
  ds_read_b64_tr_b16 v[122:123], v132 offset:704
  ds_read_b64_tr_b16 v[124:125], v132 offset:96
  ds_read_b64_tr_b16 v[126:127], v132 offset:736
  ds_read_b64_tr_b16 v[128:129], v132 offset:128
  ds_read_b64_tr_b16 v[130:131], v132 offset:768
  s_mul_i32 s46, s73, 5120
  s_add_u32 s46, s46, 39845888
  s_waitcnt lgkmcnt(0)
  s_add_u32 s47, s46, 0
  buffer_store_dwordx4 v[112:115], v133, s[24:27], s47 offen sc0 sc1
  s_add_u32 s47, s46, 1024
  buffer_store_dwordx4 v[116:119], v133, s[24:27], s47 offen sc0 sc1
  s_add_u32 s47, s46, 2048
  buffer_store_dwordx4 v[120:123], v133, s[24:27], s47 offen sc0 sc1
  s_add_u32 s47, s46, 3072
  buffer_store_dwordx4 v[124:127], v133, s[24:27], s47 offen sc0 sc1
  s_add_u32 s47, s46, 4096
  buffer_store_dwordx4 v[128:131], v133, s[24:27], s47 offen sc0 sc1
  s_nop 1
L_nojobf_38:
  v_and_b32 v4, 15, v1
  v_add_u32 v5, 16, v4
  v_lshlrev_b32 v5, 2, v5
  ds_bpermute_b32 v40, v5, v20
  ds_bpermute_b32 v41, v5, v28
  s_waitcnt lgkmcnt(0)
  v_rcp_f32 v40, v40
  v_rcp_f32 v41, v41
  s_mul_i32 s46, s53, 3
  v_lshrrev_b32 v6, 1, v2
  v_add_u32 v6, s46, v6
  v_lshlrev_b32 v6, 8, v6
  v_and_b32 v8, 1, v2
  v_lshlrev_b32 v8, 3, v8
  v_lshl_add_u32 v8, v4, 4, v8
  v_add_u32 v6, v6, v8
  s_add_u32 s46, s46, 2
  s_lshl_b32 s46, s46, 8
  v_add_u32 v7, s46, v8
  s_lshl_b32 s46, s52, 4
  s_lshl_b32 s47, s54, 1
  s_add_u32 s46, s46, s47
  s_mul_i32 s46, s46, 24576
  s_add_u32 s46, s46, 11534336
  v_cmp_eq_u32 vcc, 0, v2
  v_mul_f32 v16, v16, v40
  v_mul_f32 v17, v17, v40
  v_mul_f32 v18, v18, v40
  v_mul_f32 v19, v19, v40
  v_mul_f32 v20, v20, v40
  v_mul_f32 v21, v21, v40
  v_mul_f32 v22, v22, v40
  v_mul_f32 v23, v23, v40
  v_cvt_pk_bf16_f32 v16, v16, v17
  v_cvt_pk_bf16_f32 v17, v18, v19
  v_cvt_pk_bf16_f32 v20, v20, v21
  v_cvt_pk_bf16_f32 v21, v22, v23
  v_cndmask_b32 v20, 0, v20, vcc
  v_cndmask_b32 v21, 0, v21, vcc
  s_add_u32 s47, s46, 0
  buffer_store_dwordx2 v[16:17], v6, s[24:27], s47 offen sc0 sc1
  s_mov_b32 exec_lo, -1
  s_mov_b32 exec_hi, 0
  buffer_store_dwordx2 v[20:21], v7, s[24:27], s47 offen sc0 sc1
  s_mov_b64 exec, -1
  v_mul_f32 v24, v24, v41
  v_mul_f32 v25, v25, v41
  v_mul_f32 v26, v26, v41
  v_mul_f32 v27, v27, v41
  v_mul_f32 v28, v28, v41
  v_mul_f32 v29, v29, v41
  v_mul_f32 v30, v30, v41
  v_mul_f32 v31, v31, v41
  v_cvt_pk_bf16_f32 v24, v24, v25
  v_cvt_pk_bf16_f32 v25, v26, v27
  v_cvt_pk_bf16_f32 v28, v28, v29
  v_cvt_pk_bf16_f32 v29, v30, v31
  v_cndmask_b32 v28, 0, v28, vcc
  v_cndmask_b32 v29, 0, v29, vcc
  s_add_u32 s47, s46, 24576
  buffer_store_dwordx2 v[24:25], v6, s[24:27], s47 offen sc0 sc1
  s_mov_b32 exec_lo, -1
  s_mov_b32 exec_hi, 0
  buffer_store_dwordx2 v[28:29], v7, s[24:27], s47 offen sc0 sc1
  s_mov_b64 exec, -1
  s_waitcnt vmcnt(0)
  s_barrier
  s_lshl_b32 s78, s52, 5
  s_add_u32 s78, s78, s53
  s_cmp_lg_u32 s43, 0
  s_cbranch_scc1 L_noflag_39
  s_lshl_b32 s44, s78, 6
  s_add_u32 s44, s44, 32768
  s_mov_b32 exec_lo, 1
  s_mov_b32 exec_hi, 0
  v_mov_b32 v2, s44
  v_mov_b32 v3, s42
  buffer_store_dword v3, v2, s[24:27], 0 offen sc0 sc1
  s_mov_b64 exec, -1
L_noflag_39:
  s_add_u32 s45, s71, 409600
  s_add_u32 m0, s70, 67584
  s_nop 0
  buffer_load_dwordx4 v96, s[28:31], s45 offen lds
  s_add_u32 s45, s71, 409600
  s_add_u32 m0, s70, 68608
  s_nop 0
  buffer_load_dwordx4 v97, s[28:31], s45 offen lds
  s_add_u32 s45, s71, 409600
  s_add_u32 m0, s70, 69632
  s_mov_b64 exec, s[64:65]
  buffer_load_dwordx4 v98, s[28:31], s45 offen lds
  s_mov_b64 exec, -1
  s_add_u32 s45, s71, 409600
  s_add_u32 m0, s70, 73216
  s_nop 0
  buffer_load_dwordx4 v99, s[28:31], s45 offen lds
  s_add_u32 s45, s71, 409600
  s_add_u32 m0, s70, 74240
  s_nop 0
  buffer_load_dwordx4 v100, s[28:31], s45 offen lds
  s_add_u32 s45, s71, 409600
  s_add_u32 m0, s70, 75264
  s_mov_b64 exec, s[64:65]
  buffer_load_dwordx4 v101, s[28:31], s45 offen lds
  s_mov_b64 exec, -1
  s_add_u32 s45, s71, 409600
  s_add_u32 m0, s70, 78848
  s_nop 0
  buffer_load_dwordx4 v102, s[28:31], s45 offen lds
  s_add_u32 s45, s71, 409600
  s_add_u32 m0, s70, 79872
  s_nop 0
  buffer_load_dwordx4 v103, s[28:31], s45 offen lds
  s_add_u32 s45, s71, 409600
  s_add_u32 m0, s70, 80896
  s_mov_b64 exec, s[64:65]
  buffer_load_dwordx4 v104, s[28:31], s45 offen lds
  s_mov_b64 exec, -1
  s_mul_i32 s75, s53, 27
  s_lshr_b32 s75, s75, 2
  s_lshl_b32 s44, s75, 4
  s_add_u32 s28, s12, s44
  s_addc_u32 s29, s13, 0
  s_mov_b32 s30, 2211840
  s_mov_b32 s31, 0x20000
  s_sub_u32 s30, s30, s44
  s_add_u32 s36, s14, s44
  s_addc_u32 s37, s15, 0
  s_mov_b32 s38, 2211840
  s_mov_b32 s39, 0x20000
  s_sub_u32 s38, s38, s44
  s_lshr_b32 s45, s43, 2
  s_lshl_b32 s66, s45, 7
  s_add_u32 s57, s66, 64
  s_cmp_eq_u32 s45, 1
  s_cselect_b32 s59, 0xffff, -1
  s_mov_b32 s58, -1
  v_add_u32 v2, s66, v1
  v_mul_u32_u24 v3, 547, v2
  v_lshrrev_b32 v3, 15, v3
  v_mul_u32_u24 v4, 60, v3
  v_sub_u32 v2, v2, v4
  v_cmp_gt_u32 vcc, 56, v2
  s_nop 1
  v_cndmask_b32 v2, 0, v2, vcc
  v_mul_u32_u24 v4, 147, v2
  v_lshrrev_b32 v4, 10, v4
  v_mul_u32_u24 v5, 7, v4
  v_sub_u32 v2, v2, v5
  v_lshl_add_u32 v5, v3, 3, v4
  s_mov_b32 s44, 3456
  v_mul_lo_u32 v5, v5, s44
  v_lshl_add_u32 v208, v2, 4, v5
  v_add_u32 v2, s57, v1
  v_mul_u32_u24 v3, 547, v2
  v_lshrrev_b32 v3, 15, v3
  v_mul_u32_u24 v4, 60, v3
  v_sub_u32 v2, v2, v4
  v_cmp_gt_u32 vcc, 56, v2
  s_nop 1
  v_cndmask_b32 v2, 0, v2, vcc
  v_mul_u32_u24 v4, 147, v2
  v_lshrrev_b32 v4, 10, v4
  v_mul_u32_u24 v5, 7, v4
  v_sub_u32 v2, v2, v5
  v_lshl_add_u32 v5, v3, 3, v4
  s_mov_b32 s44, 3456
  v_mul_lo_u32 v5, v5, s44
  v_lshl_add_u32 v209, v2, 4, v5
  s_lshr_b32 s45, s43, 2
  s_and_b32 s44, s43, 3
  s_mul_i32 s70, s44, 19200
  s_lshl_b32 s45, s45, 11
  s_add_u32 s70, s70, s45
  s_mul_i32 s71, s44, 552960
  s_cmp_lg_u32 s43, 0
  s_cbranch_scc1 L_nowait_40
  v_and_b32 v4, 31, v1
  s_lshl_b32 s45, s40, 5
  v_add_u32 v4, s45, v4
  v_lshlrev_b32 v4, 6, v4
  v_add_u32 v4, 32768, v4
  s_mov_b32 s44, 40000
  s_nop 0
L_poll_41:
  buffer_load_dword v8, v4, s[24:27], 0 offen sc0 sc1
  s_waitcnt vmcnt(0)
  v_cmp_ne_u32 vcc, s42, v8
  s_cmp_eq_u64 vcc, 0
  s_nop 3
  s_cbranch_scc1 L_polld_42
  s_sub_u32 s44, s44, 1
  s_cmp_lg_u32 s44, 0
  s_cbranch_scc1 L_poll_41
L_polld_42:
L_nowait_40:
  s_barrier
  s_mul_i32 s44, s43, 320
  s_add_u32 m0, s44, 160896
  s_lshl_b32 s45, s40, 13
  s_add_u32 s44, s44, s45
  s_add_u32 s44, s44, 200448
  v_lshlrev_b32 v2, 4, v1
  s_mov_b32 exec_lo, 1048575
  s_mov_b32 exec_hi, 0
  buffer_load_dwordx4 v2, s[24:27], s44 offen lds
  s_mov_b64 exec, -1
  s_lshl_b32 s44, s62, 1
  s_add_u32 s44, s44, s60
  s_mul_i32 s44, s44, 24576
  s_mul_i32 s45, s63, 6144
  s_add_u32 s44, s44, s45
  s_add_u32 s46, s44, 11534336
  v_lshlrev_b32 v7, 4, v1
  s_add_u32 s45, s46, 0
  buffer_load_dwordx4 v[96:99], v7, s[24:27], s45 offen offset:0
  s_add_u32 s45, s46, 24576
  buffer_load_dwordx4 v[100:103], v7, s[24:27], s45 offen offset:0
  s_add_u32 s45, s46, 0
  buffer_load_dwordx4 v[104:107], v7, s[24:27], s45 offen offset:1024
  s_add_u32 s45, s46, 24576
  buffer_load_dwordx4 v[108:111], v7, s[24:27], s45 offen offset:1024
  s_add_u32 s45, s46, 0
  buffer_load_dwordx4 v[112:115], v7, s[24:27], s45 offen offset:2048
  s_add_u32 s45, s46, 24576
  buffer_load_dwordx4 v[116:119], v7, s[24:27], s45 offen offset:2048
  s_add_u32 s45, s46, 0
  buffer_load_dwordx4 v[120:123], v7, s[24:27], s45 offen offset:3072
  s_add_u32 s45, s46, 24576
  buffer_load_dwordx4 v[124:127], v7, s[24:27], s45 offen offset:3072
  s_add_u32 s45, s46, 4096
  buffer_load_dwordx4 v[128:131], v7, s[24:27], s45 offen offset:0
  s_add_u32 s45, s46, 28672
  buffer_load_dwordx4 v[132:135], v7, s[24:27], s45 offen offset:0
  s_add_u32 s45, s46, 4096
  buffer_load_dwordx4 v[136:139], v7, s[24:27], s45 offen offset:1024
  s_add_u32 s45, s46, 28672
  buffer_load_dwordx4 v[140:143], v7, s[24:27], s45 offen offset:1024
  s_mul_i32 s44, s61, 160
  s_and_b32 s45, s43, 1
  s_mul_i32 s45, s45, 96
  s_add_u32 s44, s44, s45
  v_lshrrev_b32 v2, 4, v1
  v_lshlrev_b32 v2, 3, v2
  v_add_u32 v8, s44, v2
  s_lshr_b32 s44, s43, 1
  s_add_u32 s72, s44, s60
  v_and_b32 v2, 15, v1
  s_lshl_b32 s44, s72, 4
  v_add_u32 v2, s44, v2
  s_movk_i32 s44, 1280
  v_mul_lo_u32 v2, v2, s44
  v_add_u32 v9, v2, v8
  s_mov_b32 s32, s4
  s_mov_b32 s33, s5
  s_mov_b32 s34, 2621440
  s_mov_b32 s35, 0x20000
  buffer_load_dwordx2 v[150:151], v9, s[32:35], 0 offen offset:0
  buffer_load_dwordx2 v[152:153], v9, s[32:35], 0 offen offset:32
  buffer_load_dwordx2 v[154:155], v9, s[32:35], 0 offen offset:64
  s_lshl_b32 s73, s40, 13
  s_add_u32 s74, s73, 201728
  s_add_u32 s73, s73, 199168
  buffer_load_dwordx2 v[156:157], v8, s[24:27], s73 offen offset:0
  buffer_load_dwordx2 v[162:163], v8, s[24:27], s74 offen offset:0
  buffer_load_dwordx2 v[158:159], v8, s[24:27], s73 offen offset:32
  buffer_load_dwordx2 v[164:165], v8, s[24:27], s74 offen offset:32
  buffer_load_dwordx2 v[160:161], v8, s[24:27], s73 offen offset:64
  buffer_load_dwordx2 v[166:167], v8, s[24:27], s74 offen offset:64
  v_lshrrev_b32 v2, 4, v1
  v_bfe_u32 v3, v1, 2, 2
  v_and_b32 v4, 3, v1
  v_mul_u32_u24 v2, 1408, v2
  v_mul_u32_u24 v3, 160, v3
  v_add_u32 v2, v2, v3
  v_lshl_add_u32 v2, v4, 3, v2
  s_mul_i32 s44, s63, 33792
  v_add_u32 v10, s44, v2
  v_mov_b32 v16, 0
  v_mov_b32 v17, 0
  v_mov_b32 v18, 0
  v_mov_b32 v19, 0
  v_mov_b32 v20, 0
  v_mov_b32 v21, 0
  v_mov_b32 v22, 0
  v_mov_b32 v23, 0
  v_mov_b32 v24, 0
  v_mov_b32 v25, 0
  v_mov_b32 v26, 0
  v_mov_b32 v27, 0
  v_mov_b32 v28, 0
  v_mov_b32 v29, 0
  v_mov_b32 v30, 0
  v_mov_b32 v31, 0
  v_mov_b32 v32, 0
  v_mov_b32 v33, 0
  v_mov_b32 v34, 0
  v_mov_b32 v35, 0
  v_mov_b32 v36, 0
  v_mov_b32 v37, 0
  v_mov_b32 v38, 0
  v_mov_b32 v39, 0
  v_mov_b32 v40, 0
  v_mov_b32 v41, 0
  v_mov_b32 v42, 0
  v_mov_b32 v43, 0
  v_mov_b32 v44, 0
  v_mov_b32 v45, 0
  v_mov_b32 v46, 0
  v_mov_b32 v47, 0
  v_mov_b32 v48, 0
  v_mov_b32 v49, 0
  v_mov_b32 v50, 0
  v_mov_b32 v51, 0
  v_mov_b32 v52, 0
  v_mov_b32 v53, 0
  v_mov_b32 v54, 0
  v_mov_b32 v55, 0
  s_waitcnt vmcnt(22)
  s_barrier
  ds_read_b64_tr_b16 v[56:57], v10 offset:0
  ds_read_b64_tr_b16 v[58:59], v10 offset:640
  ds_read_b64_tr_b16 v[60:61], v10 offset:32
  ds_read_b64_tr_b16 v[62:63], v10 offset:672
  ds_read_b64_tr_b16 v[64:65], v10 offset:64
  ds_read_b64_tr_b16 v[66:67], v10 offset:704
  ds_read_b64_tr_b16 v[68:69], v10 offset:96
  ds_read_b64_tr_b16 v[70:71], v10 offset:736
  ds_read_b64_tr_b16 v[72:73], v10 offset:128
  ds_read_b64_tr_b16 v[74:75], v10 offset:768
  s_waitcnt lgkmcnt(0)
  s_waitcnt vmcnt(19)
  v_mfma_f32_16x16x32_bf16 v[16:19], v[56:59], v[96:99], v[16:19]
  ds_read_b64_tr_b16 v[76:77], v10 offset:5632
  ds_read_b64_tr_b16 v[78:79], v10 offset:6272
  v_mfma_f32_16x16x32_bf16 v[36:39], v[56:59], v[100:103], v[36:39]
  ds_read_b64_tr_b16 v[80:81], v10 offset:5664
  ds_read_b64_tr_b16 v[82:83], v10 offset:6304
  v_mfma_f32_16x16x32_bf16 v[20:23], v[60:63], v[96:99], v[20:23]
  ds_read_b64_tr_b16 v[84:85], v10 offset:5696
  ds_read_b64_tr_b16 v[86:87], v10 offset:6336
  v_mfma_f32_16x16x32_bf16 v[40:43], v[60:63], v[100:103], v[40:43]
  ds_read_b64_tr_b16 v[88:89], v10 offset:5728
  ds_read_b64_tr_b16 v[90:91], v10 offset:6368
  v_mfma_f32_16x16x32_bf16 v[24:27], v[64:67], v[96:99], v[24:27]
  ds_read_b64_tr_b16 v[92:93], v10 offset:5760
  ds_read_b64_tr_b16 v[94:95], v10 offset:6400
  v_mfma_f32_16x16x32_bf16 v[44:47], v[64:67], v[100:103], v[44:47]
  v_mfma_f32_16x16x32_bf16 v[28:31], v[68:71], v[96:99], v[28:31]
  v_mfma_f32_16x16x32_bf16 v[48:51], v[68:71], v[100:103], v[48:51]
  v_mfma_f32_16x16x32_bf16 v[32:35], v[72:75], v[96:99], v[32:35]
  v_mfma_f32_16x16x32_bf16 v[52:55], v[72:75], v[100:103], v[52:55]
  s_waitcnt lgkmcnt(0)
  s_waitcnt vmcnt(17)
  v_mfma_f32_16x16x32_bf16 v[16:19], v[76:79], v[104:107], v[16:19]
  ds_read_b64_tr_b16 v[56:57], v10 offset:11264
  ds_read_b64_tr_b16 v[58:59], v10 offset:11904
  v_mfma_f32_16x16x32_bf16 v[36:39], v[76:79], v[108:111], v[36:39]
  ds_read_b64_tr_b16 v[60:61], v10 offset:11296
  ds_read_b64_tr_b16 v[62:63], v10 offset:11936
  v_mfma_f32_16x16x32_bf16 v[20:23], v[80:83], v[104:107], v[20:23]
  ds_read_b64_tr_b16 v[64:65], v10 offset:11328
  ds_read_b64_tr_b16 v[66:67], v10 offset:11968
  v_mfma_f32_16x16x32_bf16 v[40:43], v[80:83], v[108:111], v[40:43]
  ds_read_b64_tr_b16 v[68:69], v10 offset:11360
  ds_read_b64_tr_b16 v[70:71], v10 offset:12000
  v_mfma_f32_16x16x32_bf16 v[24:27], v[84:87], v[104:107], v[24:27]
  ds_read_b64_tr_b16 v[72:73], v10 offset:11392
  ds_read_b64_tr_b16 v[74:75], v10 offset:12032
  v_mfma_f32_16x16x32_bf16 v[44:47], v[84:87], v[108:111], v[44:47]
  v_mfma_f32_16x16x32_bf16 v[28:31], v[88:91], v[104:107], v[28:31]
  v_mfma_f32_16x16x32_bf16 v[48:51], v[88:91], v[108:111], v[48:51]
  v_mfma_f32_16x16x32_bf16 v[32:35], v[92:95], v[104:107], v[32:35]
  v_mfma_f32_16x16x32_bf16 v[52:55], v[92:95], v[108:111], v[52:55]
  s_waitcnt lgkmcnt(0)
  s_waitcnt vmcnt(15)
  v_mfma_f32_16x16x32_bf16 v[16:19], v[56:59], v[112:115], v[16:19]
  ds_read_b64_tr_b16 v[76:77], v10 offset:16896
  ds_read_b64_tr_b16 v[78:79], v10 offset:17536
  v_mfma_f32_16x16x32_bf16 v[36:39], v[56:59], v[116:119], v[36:39]
  ds_read_b64_tr_b16 v[80:81], v10 offset:16928
  ds_read_b64_tr_b16 v[82:83], v10 offset:17568
  v_mfma_f32_16x16x32_bf16 v[20:23], v[60:63], v[112:115], v[20:23]
  ds_read_b64_tr_b16 v[84:85], v10 offset:16960
  ds_read_b64_tr_b16 v[86:87], v10 offset:17600
  v_mfma_f32_16x16x32_bf16 v[40:43], v[60:63], v[116:119], v[40:43]
  ds_read_b64_tr_b16 v[88:89], v10 offset:16992
  ds_read_b64_tr_b16 v[90:91], v10 offset:17632
  v_mfma_f32_16x16x32_bf16 v[24:27], v[64:67], v[112:115], v[24:27]
  ds_read_b64_tr_b16 v[92:93], v10 offset:17024
  ds_read_b64_tr_b16 v[94:95], v10 offset:17664
  v_mfma_f32_16x16x32_bf16 v[44:47], v[64:67], v[116:119], v[44:47]
  v_mfma_f32_16x16x32_bf16 v[28:31], v[68:71], v[112:115], v[28:31]
  v_mfma_f32_16x16x32_bf16 v[48:51], v[68:71], v[116:119], v[48:51]
  v_mfma_f32_16x16x32_bf16 v[32:35], v[72:75], v[112:115], v[32:35]
  v_mfma_f32_16x16x32_bf16 v[52:55], v[72:75], v[116:119], v[52:55]
  s_waitcnt lgkmcnt(0)
  s_waitcnt vmcnt(13)
  v_mfma_f32_16x16x32_bf16 v[16:19], v[76:79], v[120:123], v[16:19]
  ds_read_b64_tr_b16 v[56:57], v10 offset:22528
  ds_read_b64_tr_b16 v[58:59], v10 offset:23168
  v_mfma_f32_16x16x32_bf16 v[36:39], v[76:79], v[124:127], v[36:39]
  ds_read_b64_tr_b16 v[60:61], v10 offset:22560
  ds_read_b64_tr_b16 v[62:63], v10 offset:23200
  v_mfma_f32_16x16x32_bf16 v[20:23], v[80:83], v[120:123], v[20:23]
  ds_read_b64_tr_b16 v[64:65], v10 offset:22592
  ds_read_b64_tr_b16 v[66:67], v10 offset:23232
  v_mfma_f32_16x16x32_bf16 v[40:43], v[80:83], v[124:127], v[40:43]
  ds_read_b64_tr_b16 v[68:69], v10 offset:22624
  ds_read_b64_tr_b16 v[70:71], v10 offset:23264
  v_mfma_f32_16x16x32_bf16 v[24:27], v[84:87], v[120:123], v[24:27]
  ds_read_b64_tr_b16 v[72:73], v10 offset:22656
  ds_read_b64_tr_b16 v[74:75], v10 offset:23296
  v_mfma_f32_16x16x32_bf16 v[44:47], v[84:87], v[124:127], v[44:47]
  v_mfma_f32_16x16x32_bf16 v[28:31], v[88:91], v[120:123], v[28:31]
  v_mfma_f32_16x16x32_bf16 v[48:51], v[88:91], v[124:127], v[48:51]
  v_mfma_f32_16x16x32_bf16 v[32:35], v[92:95], v[120:123], v[32:35]
  v_mfma_f32_16x16x32_bf16 v[52:55], v[92:95], v[124:127], v[52:55]
  s_waitcnt lgkmcnt(0)
  s_waitcnt vmcnt(11)
  v_mfma_f32_16x16x32_bf16 v[16:19], v[56:59], v[128:131], v[16:19]
  ds_read_b64_tr_b16 v[76:77], v10 offset:28160
  ds_read_b64_tr_b16 v[78:79], v10 offset:28800
  v_mfma_f32_16x16x32_bf16 v[36:39], v[56:59], v[132:135], v[36:39]
  ds_read_b64_tr_b16 v[80:81], v10 offset:28192
  ds_read_b64_tr_b16 v[82:83], v10 offset:28832
  v_mfma_f32_16x16x32_bf16 v[20:23], v[60:63], v[128:131], v[20:23]
  ds_read_b64_tr_b16 v[84:85], v10 offset:28224
  ds_read_b64_tr_b16 v[86:87], v10 offset:28864
  v_mfma_f32_16x16x32_bf16 v[40:43], v[60:63], v[132:135], v[40:43]
  ds_read_b64_tr_b16 v[88:89], v10 offset:28256
  ds_read_b64_tr_b16 v[90:91], v10 offset:28896
  v_mfma_f32_16x16x32_bf16 v[24:27], v[64:67], v[128:131], v[24:27]
  ds_read_b64_tr_b16 v[92:93], v10 offset:28288
  ds_read_b64_tr_b16 v[94:95], v10 offset:28928
  v_mfma_f32_16x16x32_bf16 v[44:47], v[64:67], v[132:135], v[44:47]
  v_mfma_f32_16x16x32_bf16 v[28:31], v[68:71], v[128:131], v[28:31]
  v_mfma_f32_16x16x32_bf16 v[48:51], v[68:71], v[132:135], v[48:51]
  v_mfma_f32_16x16x32_bf16 v[32:35], v[72:75], v[128:131], v[32:35]
  v_mfma_f32_16x16x32_bf16 v[52:55], v[72:75], v[132:135], v[52:55]
  s_waitcnt lgkmcnt(0)
  s_waitcnt vmcnt(9)
  v_mfma_f32_16x16x32_bf16 v[16:19], v[76:79], v[136:139], v[16:19]
  v_mfma_f32_16x16x32_bf16 v[36:39], v[76:79], v[140:143], v[36:39]
  v_mfma_f32_16x16x32_bf16 v[20:23], v[80:83], v[136:139], v[20:23]
  v_mfma_f32_16x16x32_bf16 v[40:43], v[80:83], v[140:143], v[40:43]
  v_mfma_f32_16x16x32_bf16 v[24:27], v[84:87], v[136:139], v[24:27]
  v_mfma_f32_16x16x32_bf16 v[44:47], v[84:87], v[140:143], v[44:47]
  v_mfma_f32_16x16x32_bf16 v[28:31], v[88:91], v[136:139], v[28:31]
  v_mfma_f32_16x16x32_bf16 v[48:51], v[88:91], v[140:143], v[48:51]
  v_mfma_f32_16x16x32_bf16 v[32:35], v[92:95], v[136:139], v[32:35]
  v_mfma_f32_16x16x32_bf16 v[52:55], v[92:95], v[140:143], v[52:55]
  v_mov_b32 v240, 0
  v_mov_b32 v241, 0
  v_mov_b32 v242, 0
  v_mov_b32 v243, 0
  s_cmp_lg_u32 s43, 1
  s_nop 2
  s_cbranch_scc1 L_nochk0_44
  v_add_u32 v236, 0, v1
  v_lshlrev_b32 v236, 6, v236
  v_add_u32 v236, 32768, v236
  buffer_load_dword v240, v236, s[24:27], 0 offen sc0 sc1
  v_add_u32 v237, 64, v1
  v_lshlrev_b32 v237, 6, v237
  v_add_u32 v237, 32768, v237
  buffer_load_dword v241, v237, s[24:27], 0 offen sc0 sc1
  v_add_u32 v238, 128, v1
  v_lshlrev_b32 v238, 6, v238
  v_add_u32 v238, 32768, v238
  buffer_load_dword v242, v238, s[24:27], 0 offen sc0 sc1
  v_add_u32 v239, 192, v1
  v_lshlrev_b32 v239, 6, v239
  v_add_u32 v239, 32768, v239
  buffer_load_dword v243, v239, s[24:27], 0 offen sc0 sc1
  s_nop 0
L_nochk0_44:
  s_barrier
  s_mul_i32 s44, s43, 10240
  v_lshlrev_b32 v2, 4, v1
  v_add_u32 v3, s44, v2
  ds_write_b128 v3, v[16:19] offset:0
  s_add_u32 s45, s71, 0
  s_add_u32 m0, s70, 82048
  s_nop 0
  buffer_load_dwordx4 v208, s[36:39], s45 offen lds
  ds_write_b128 v3, v[20:23] offset:1024
  s_add_u32 s45, s71, 0
  s_add_u32 m0, s70, 83072
  s_mov_b64 exec, s[58:59]
  buffer_load_dwordx4 v209, s[36:39], s45 offen lds
  s_mov_b64 exec, -1
  ds_write_b128 v3, v[24:27] offset:2048
  s_add_u32 s45, s71, 110592
  s_add_u32 m0, s70, 85888
  s_nop 0
  buffer_load_dwordx4 v208, s[36:39], s45 offen lds
  ds_write_b128 v3, v[28:31] offset:3072
  s_add_u32 s45, s71, 110592
  s_add_u32 m0, s70, 86912
  s_mov_b64 exec, s[58:59]
  buffer_load_dwordx4 v209, s[36:39], s45 offen lds
  s_mov_b64 exec, -1
  ds_write_b128 v3, v[32:35] offset:4096
  s_add_u32 s45, s71, 221184
  s_add_u32 m0, s70, 89728
  s_nop 0
  buffer_load_dwordx4 v208, s[36:39], s45 offen lds
  ds_write_b128 v3, v[36:39] offset:5120
  s_add_u32 s45, s71, 221184
  s_add_u32 m0, s70, 90752
  s_mov_b64 exec, s[58:59]
  buffer_load_dwordx4 v209, s[36:39], s45 offen lds
  s_mov_b64 exec, -1
  ds_write_b128 v3, v[40:43] offset:6144
  s_add_u32 s45, s71, 331776
  s_add_u32 m0, s70, 93568
  s_nop 0
  buffer_load_dwordx4 v208, s[36:39], s45 offen lds
  ds_write_b128 v3, v[44:47] offset:7168
  s_add_u32 s45, s71, 331776
  s_add_u32 m0, s70, 94592
  s_mov_b64 exec, s[58:59]
  buffer_load_dwordx4 v209, s[36:39], s45 offen lds
  s_mov_b64 exec, -1
  ds_write_b128 v3, v[48:51] offset:8192
  s_add_u32 s45, s71, 442368
  s_add_u32 m0, s70, 97408
  s_nop 0
  buffer_load_dwordx4 v208, s[36:39], s45 offen lds
  ds_write_b128 v3, v[52:55] offset:9216
  s_add_u32 s45, s71, 442368
  s_add_u32 m0, s70, 98432
  s_mov_b64 exec, s[58:59]
  buffer_load_dwordx4 v209, s[36:39], s45 offen lds
  s_mov_b64 exec, -1
  s_lshr_b32 s44, s43, 2
  s_mul_i32 s44, s44, 10240
  s_bfe_u32 s45, s43, 0x10001
  s_mul_i32 s45, s45, 5120
  s_add_u32 s44, s44, s45
  s_and_b32 s45, s43, 1
  s_mul_i32 s45, s45, 3072
  s_add_u32 s44, s44, s45
  v_add_u32 v3, s44, v2
  s_waitcnt lgkmcnt(0)
  s_barrier
  ds_read_b128 v[56:59], v3 offset:0
  ds_read_b128 v[60:63], v3 offset:1024
  ds_read_b128 v[64:67], v3 offset:2048
  ds_read_b128 v[68:71], v3 offset:20480
  ds_read_b128 v[72:75], v3 offset:21504
  ds_read_b128 v[76:79], v3 offset:22528
  ds_read_b128 v[80:83], v3 offset:40960
  ds_read_b128 v[84:87], v3 offset:41984
  ds_read_b128 v[88:91], v3 offset:43008
  ds_read_b128 v[92:95], v3 offset:61440
  ds_read_b128 v[96:99], v3 offset:62464
  ds_read_b128 v[100:103], v3 offset:63488
  s_waitcnt lgkmcnt(0)
  v_add_f32 v16, v56, v68
  v_add_f32 v32, v80, v92
  v_add_f32 v16, v16, v32
  v_add_f32 v17, v57, v69
  v_add_f32 v33, v81, v93
  v_add_f32 v17, v17, v33
  v_add_f32 v18, v58, v70
  v_add_f32 v34, v82, v94
  v_add_f32 v18, v18, v34
  v_add_f32 v19, v59, v71
  v_add_f32 v35, v83, v95
  v_add_f32 v19, v19, v35
  v_add_f32 v20, v60, v72
  v_add_f32 v36, v84, v96
  v_add_f32 v20, v20, v36
  v_add_f32 v21, v61, v73
  v_add_f32 v37, v85, v97
  v_add_f32 v21, v21, v37
  v_add_f32 v22, v62, v74
  v_add_f32 v38, v86, v98
  v_add_f32 v22, v22, v38
  v_add_f32 v23, v63, v75
  v_add_f32 v39, v87, v99
  v_add_f32 v23, v23, v39
  v_add_f32 v24, v64, v76
  v_add_f32 v40, v88, v100
  v_add_f32 v24, v24, v40
  v_add_f32 v25, v65, v77
  v_add_f32 v41, v89, v101
  v_add_f32 v25, v25, v41
  v_add_f32 v26, v66, v78
  v_add_f32 v42, v90, v102
  v_add_f32 v26, v26, v42
  v_add_f32 v27, v67, v79
  v_add_f32 v43, v91, v103
  v_add_f32 v27, v27, v43
  s_barrier
  s_waitcnt vmcnt(10)
  v_mov_b32 v12, 0
  v_mov_b32 v13, 0
  s_mul_i32 s46, s72, 20480
  s_add_u32 s46, s46, 15728640
  s_mul_i32 s44, s61, 5
  s_and_b32 s45, s43, 1
  s_mul_i32 s45, s45, 3
  s_add_u32 s44, s44, s45
  s_lshl_b32 s44, s44, 9
  v_lshrrev_b32 v2, 5, v1
  v_lshlrev_b32 v2, 8, v2
  v_and_b32 v3, 15, v1
  v_lshl_add_u32 v2, v3, 4, v2
  v_bfe_u32 v3, v1, 4, 1
  v_lshl_add_u32 v2, v3, 3, v2
  v_add_u32 v11, s44, v2
  v_cvt_pk_bf16_f32 v2, v16, v17
  v_lshlrev_b32 v16, 16, v2
  v_and_b32 v17, 0xffff0000, v2
  v_cvt_pk_bf16_f32 v2, v18, v19
  v_lshlrev_b32 v18, 16, v2
  v_and_b32 v19, 0xffff0000, v2
  v_lshlrev_b32 v32, 16, v156
  v_and_b32 v33, 0xffff0000, v156
  v_lshlrev_b32 v34, 16, v157
  v_and_b32 v35, 0xffff0000, v157
  v_mul_f32 v16, v16, v32
  v_mul_f32 v17, v17, v33
  v_mul_f32 v18, v18, v34
  v_mul_f32 v19, v19, v35
  v_cvt_pk_bf16_f32 v2, v16, v17
  v_lshlrev_b32 v16, 16, v2
  v_and_b32 v17, 0xffff0000, v2
  v_cvt_pk_bf16_f32 v2, v18, v19
  v_lshlrev_b32 v18, 16, v2
  v_and_b32 v19, 0xffff0000, v2
  v_lshlrev_b32 v32, 16, v150
  v_and_b32 v33, 0xffff0000, v150
  v_lshlrev_b32 v34, 16, v151
  v_and_b32 v35, 0xffff0000, v151
  v_add_f32 v244, v16, v32
  v_add_f32 v245, v17, v33
  v_add_f32 v246, v18, v34
  v_add_f32 v247, v19, v35
  v_cvt_pk_bf16_f32 v2, v244, v245
  v_lshlrev_b32 v244, 16, v2
  v_and_b32 v245, 0xffff0000, v2
  v_cvt_pk_bf16_f32 v2, v246, v247
  v_lshlrev_b32 v246, 16, v2
  v_and_b32 v247, 0xffff0000, v2
  v_add_f32 v12, v12, v244
  v_fmac_f32 v13, v244, v244
  v_add_f32 v12, v12, v245
  v_fmac_f32 v13, v245, v245
  v_add_f32 v12, v12, v246
  v_fmac_f32 v13, v246, v246
  v_add_f32 v12, v12, v247
  v_fmac_f32 v13, v247, v247
  v_lshlrev_b32 v32, 16, v162
  v_and_b32 v33, 0xffff0000, v162
  v_lshlrev_b32 v34, 16, v163
  v_and_b32 v35, 0xffff0000, v163
  v_mul_f32 v32, v32, v244
  v_mul_f32 v33, v33, v245
  v_mul_f32 v34, v34, v246
  v_mul_f32 v35, v35, v247
  v_cvt_pk_bf16_f32 v36, v32, v33
  v_cvt_pk_bf16_f32 v37, v34, v35
  buffer_store_dwordx2 v[36:37], v11, s[24:27], s46 offen offset:0 sc0 sc1
  v_cvt_pk_bf16_f32 v2, v20, v21
  v_lshlrev_b32 v20, 16, v2
  v_and_b32 v21, 0xffff0000, v2
  v_cvt_pk_bf16_f32 v2, v22, v23
  v_lshlrev_b32 v22, 16, v2
  v_and_b32 v23, 0xffff0000, v2
  v_lshlrev_b32 v32, 16, v158
  v_and_b32 v33, 0xffff0000, v158
  v_lshlrev_b32 v34, 16, v159
  v_and_b32 v35, 0xffff0000, v159
  v_mul_f32 v20, v20, v32
  v_mul_f32 v21, v21, v33
  v_mul_f32 v22, v22, v34
  v_mul_f32 v23, v23, v35
  v_cvt_pk_bf16_f32 v2, v20, v21
  v_lshlrev_b32 v20, 16, v2
  v_and_b32 v21, 0xffff0000, v2
  v_cvt_pk_bf16_f32 v2, v22, v23
  v_lshlrev_b32 v22, 16, v2
  v_and_b32 v23, 0xffff0000, v2
  v_lshlrev_b32 v32, 16, v152
  v_and_b32 v33, 0xffff0000, v152
  v_lshlrev_b32 v34, 16, v153
  v_and_b32 v35, 0xffff0000, v153
  v_add_f32 v248, v20, v32
  v_add_f32 v249, v21, v33
  v_add_f32 v250, v22, v34
  v_add_f32 v251, v23, v35
  v_cvt_pk_bf16_f32 v2, v248, v249
  v_lshlrev_b32 v248, 16, v2
  v_and_b32 v249, 0xffff0000, v2
  v_cvt_pk_bf16_f32 v2, v250, v251
  v_lshlrev_b32 v250, 16, v2
  v_and_b32 v251, 0xffff0000, v2
  v_add_f32 v12, v12, v248
  v_fmac_f32 v13, v248, v248
  v_add_f32 v12, v12, v249
  v_fmac_f32 v13, v249, v249
  v_add_f32 v12, v12, v250
  v_fmac_f32 v13, v250, v250
  v_add_f32 v12, v12, v251
  v_fmac_f32 v13, v251, v251
  v_lshlrev_b32 v32, 16, v164
  v_and_b32 v33, 0xffff0000, v164
  v_lshlrev_b32 v34, 16, v165
  v_and_b32 v35, 0xffff0000, v165
  v_mul_f32 v32, v32, v248
  v_mul_f32 v33, v33, v249
  v_mul_f32 v34, v34, v250
  v_mul_f32 v35, v35, v251
  v_cvt_pk_bf16_f32 v38, v32, v33
  v_cvt_pk_bf16_f32 v39, v34, v35
  buffer_store_dwordx2 v[38:39], v11, s[24:27], s46 offen offset:512 sc0 sc1
  s_bitcmp1_b32 s43, 0
  s_cbranch_scc1 L_p3e_45
  v_cvt_pk_bf16_f32 v2, v24, v25
  v_lshlrev_b32 v24, 16, v2
  v_and_b32 v25, 0xffff0000, v2
  v_cvt_pk_bf16_f32 v2, v26, v27
  v_lshlrev_b32 v26, 16, v2
  v_and_b32 v27, 0xffff0000, v2
  v_lshlrev_b32 v32, 16, v160
  v_and_b32 v33, 0xffff0000, v160
  v_lshlrev_b32 v34, 16, v161
  v_and_b32 v35, 0xffff0000, v161
  v_mul_f32 v24, v24, v32
  v_mul_f32 v25, v25, v33
  v_mul_f32 v26, v26, v34
  v_mul_f32 v27, v27, v35
  v_cvt_pk_bf16_f32 v2, v24, v25
  v_lshlrev_b32 v24, 16, v2
  v_and_b32 v25, 0xffff0000, v2
  v_cvt_pk_bf16_f32 v2, v26, v27
  v_lshlrev_b32 v26, 16, v2
  v_and_b32 v27, 0xffff0000, v2
  v_lshlrev_b32 v32, 16, v154
  v_and_b32 v33, 0xffff0000, v154
  v_lshlrev_b32 v34, 16, v155
  v_and_b32 v35, 0xffff0000, v155
  v_add_f32 v252, v24, v32
  v_add_f32 v253, v25, v33
  v_add_f32 v254, v26, v34
  v_add_f32 v255, v27, v35
  v_cvt_pk_bf16_f32 v2, v252, v253
  v_lshlrev_b32 v252, 16, v2
  v_and_b32 v253, 0xffff0000, v2
  v_cvt_pk_bf16_f32 v2, v254, v255
  v_lshlrev_b32 v254, 16, v2
  v_and_b32 v255, 0xffff0000, v2
  v_add_f32 v12, v12, v252
  v_fmac_f32 v13, v252, v252
  v_add_f32 v12, v12, v253
  v_fmac_f32 v13, v253, v253
  v_add_f32 v12, v12, v254
  v_fmac_f32 v13, v254, v254
  v_add_f32 v12, v12, v255
  v_fmac_f32 v13, v255, v255
  v_lshlrev_b32 v32, 16, v166
  v_and_b32 v33, 0xffff0000, v166
  v_lshlrev_b32 v34, 16, v167
  v_and_b32 v35, 0xffff0000, v167
  v_mul_f32 v32, v32, v252
  v_mul_f32 v33, v33, v253
  v_mul_f32 v34, v34, v254
  v_mul_f32 v35, v35, v255
  v_cvt_pk_bf16_f32 v40, v32, v33
  v_cvt_pk_bf16_f32 v41, v34, v35
  buffer_store_dwordx2 v[40:41], v11, s[24:27], s46 offen offset:1024 sc0 sc1
  s_nop 0
L_p3e_45:
  v_mov_b32 v2, v12
  s_nop 1
  v_permlane16_swap_b32 v12, v2
  v_add_f32 v12, v12, v2
  v_mov_b32 v2, v12
  s_nop 1
  v_permlane32_swap_b32 v12, v2
  v_add_f32 v12, v12, v2
  v_mov_b32 v2, v13
  s_nop 1
  v_permlane16_swap_b32 v13, v2
  v_add_f32 v13, v13, v2
  v_mov_b32 v2, v13
  s_nop 1
  v_permlane32_swap_b32 v13, v2
  v_add_f32 v13, v13, v2
  s_lshl_b32 s44, s61, 1
  s_and_b32 s45, s43, 1
  s_add_u32 s44, s44, s45
  s_lshl_b32 s45, s72, 4
  s_add_u32 s44, s44, s45
  s_lshl_b32 s44, s44, 7
  s_add_u32 s44, s44, 18874368
  v_lshlrev_b32 v2, 3, v1
  s_mov_b32 exec_lo, 65535
  s_mov_b32 exec_hi, 0
  buffer_store_dwordx2 v[12:13], v2, s[24:27], s44 offen sc0 sc1
  s_mov_b64 exec, -1
  s_waitcnt vmcnt(0)
  s_barrier
  s_lshl_b32 s78, s40, 5
  s_add_u32 s78, s78, s41
  s_cmp_lg_u32 s43, 0
  s_cbranch_scc1 L_noflag_46
  s_lshl_b32 s44, s78, 6
  s_add_u32 s44, s44, 49152
  s_mov_b32 exec_lo, 1
  s_mov_b32 exec_hi, 0
  v_mov_b32 v2, s44
  v_mov_b32 v3, s42
  buffer_store_dword v3, v2, s[24:27], 0 offen sc0 sc1
  s_mov_b64 exec, -1
L_noflag_46:
  s_add_u32 s45, s71, 0
  s_add_u32 m0, s70, 0
  s_nop 0
  buffer_load_dwordx4 v208, s[28:31], s45 offen lds
  s_add_u32 s45, s71, 0
  s_add_u32 m0, s70, 1024
  s_mov_b64 exec, s[58:59]
  buffer_load_dwordx4 v209, s[28:31], s45 offen lds
  s_mov_b64 exec, -1
  s_add_u32 s45, s71, 110592
  s_add_u32 m0, s70, 3840
  s_nop 0
  buffer_load_dwordx4 v208, s[28:31], s45 offen lds
  s_add_u32 s45, s71, 110592
  s_add_u32 m0, s70, 4864
  s_mov_b64 exec, s[58:59]
  buffer_load_dwordx4 v209, s[28:31], s45 offen lds
  s_mov_b64 exec, -1
  s_add_u32 s45, s71, 221184
  s_add_u32 m0, s70, 7680
  s_nop 0
  buffer_load_dwordx4 v208, s[28:31], s45 offen lds
  s_add_u32 s45, s71, 221184
  s_add_u32 m0, s70, 8704
  s_mov_b64 exec, s[58:59]
  buffer_load_dwordx4 v209, s[28:31], s45 offen lds
  s_mov_b64 exec, -1
  s_add_u32 s45, s71, 331776
  s_add_u32 m0, s70, 11520
  s_nop 0
  buffer_load_dwordx4 v208, s[28:31], s45 offen lds
  s_add_u32 s45, s71, 331776
  s_add_u32 m0, s70, 12544
  s_mov_b64 exec, s[58:59]
  buffer_load_dwordx4 v209, s[28:31], s45 offen lds
  s_mov_b64 exec, -1
  s_add_u32 s45, s71, 442368
  s_add_u32 m0, s70, 15360
  s_nop 0
  buffer_load_dwordx4 v208, s[28:31], s45 offen lds
  s_add_u32 s45, s71, 442368
  s_add_u32 m0, s70, 16384
  s_mov_b64 exec, s[58:59]
  buffer_load_dwordx4 v209, s[28:31], s45 offen lds
  s_mov_b64 exec, -1
  v_lshrrev_b32 v2, 4, v1
  v_bfe_u32 v3, v1, 2, 2
  v_and_b32 v4, 1, v1
  v_bfe_u32 v5, v1, 1, 1
  v_mul_u32_u24 v2, 960, v2
  v_mul_u32_u24 v3, 112, v3
  v_add_u32 v2, v2, v3
  v_lshl_add_u32 v2, v4, 3, v2
  s_mov_b32 s44, 82048
  v_mul_lo_u32 v5, v5, s44
  v_add_u32 v14, v2, v5
  v_add_u32 v15, 38400, v14
  s_cmp_lg_u32 s43, 0
  s_nop 0
  s_cbranch_scc1 L_nowait_47
  v_and_b32 v4, 31, v1
  s_lshl_b32 s45, s52, 5
  v_add_u32 v4, s45, v4
  v_lshlrev_b32 v4, 6, v4
  v_add_u32 v4, 49152, v4
  s_mov_b32 s44, 40000
  s_nop 0
L_poll_48:
  buffer_load_dword v8, v4, s[24:27], 0 offen sc0 sc1
  s_waitcnt vmcnt(0)
  v_cmp_ne_u32 vcc, s42, v8
  s_cmp_eq_u64 vcc, 0
  s_nop 3
  s_cbranch_scc1 L_polld_49
  s_sub_u32 s44, s44, 1
  s_cmp_lg_u32 s44, 0
  s_cbranch_scc1 L_poll_48
L_polld_49:
  s_branch L_wfend_50
L_nowait_47:
  s_cmp_lg_u32 s43, 1
  s_cbranch_scc1 L_nochk_51
  v_cmp_ne_u32 vcc, s42, v240
  v_cmp_ne_u32 s[46:47], s42, v241
  s_nop 0
  s_or_b64 vcc, vcc, s[46:47]
  v_cmp_ne_u32 s[46:47], s42, v242
  s_nop 0
  s_or_b64 vcc, vcc, s[46:47]
  v_cmp_ne_u32 s[46:47], s42, v243
  s_nop 0
  s_or_b64 vcc, vcc, s[46:47]
  s_cmp_eq_u64 vcc, 0
  s_nop 1
  s_cbranch_scc1 L_nochk_51
  v_add_u32 v4, 0, v1
  v_lshlrev_b32 v4, 6, v4
  v_add_u32 v4, 32768, v4
  v_add_u32 v5, 64, v1
  v_lshlrev_b32 v5, 6, v5
  v_add_u32 v5, 32768, v5
  v_add_u32 v6, 128, v1
  v_lshlrev_b32 v6, 6, v6
  v_add_u32 v6, 32768, v6
  v_add_u32 v7, 192, v1
  v_lshlrev_b32 v7, 6, v7
  v_add_u32 v7, 32768, v7
  s_mov_b32 s44, 40000
  s_nop 0
L_chk_52:
  buffer_load_dword v8, v4, s[24:27], 0 offen sc0 sc1
  buffer_load_dword v9, v5, s[24:27], 0 offen sc0 sc1
  buffer_load_dword v10, v6, s[24:27], 0 offen sc0 sc1
  buffer_load_dword v11, v7, s[24:27], 0 offen sc0 sc1
  s_waitcnt vmcnt(0)
  v_cmp_ne_u32 vcc, s42, v8
  v_cmp_ne_u32 s[46:47], s42, v9
  s_nop 0
  s_or_b64 vcc, vcc, s[46:47]
  v_cmp_ne_u32 s[46:47], s42, v10
  s_nop 0
  s_or_b64 vcc, vcc, s[46:47]
  v_cmp_ne_u32 s[46:47], s42, v11
  s_nop 0
  s_or_b64 vcc, vcc, s[46:47]
  s_cmp_eq_u64 vcc, 0
  s_nop 1
  s_cbranch_scc1 L_nochk_51
  s_sub_u32 s44, s44, 1
  s_cmp_lg_u32 s44, 0
  s_cbranch_scc1 L_chk_52
L_nochk_51:
L_wfend_50:
  s_barrier
  s_lshl_b32 s44, s62, 11
  v_lshl_add_u32 v11, v1, 4, s44
  s_mul_i32 s77, s63, 14
  s_cmp_eq_u32 s63, 3
  s_cselect_b32 s77, 41, s77
  s_mul_i32 s49, s63, 35840
  s_add_u32 s49, s49, s44
  s_mul_i32 s50, s61, 54
  s_add_u32 s50, s50, s77
  s_mul_i32 s50, s50, 5120
  s_add_u32 s50, s50, 39845888
  s_add_u32 s51, s50, 66560
  s_cmp_ge_u32 s63, 2
  s_cselect_b32 s51, s50, s51
  s_min_u32 s44, s43, 6
  s_lshl_b32 s44, s44, 4
  v_add_u32 v9, s44, v14
  v_add_u32 v10, s44, v15
  v_and_b32 v2, 1, v1
  v_xor_b32 v2, 1, v2
  v_mul_u32_u24 v2, 1280, v2
  v_lshrrev_b32 v3, 4, v1
  v_lshl_add_u32 v2, v3, 4, v2
  v_add_u32 v6, 160896, v2
  s_lshl_b32 s44, s52, 4
  s_lshl_b32 s45, s43, 1
  s_add_u32 s76, s44, s45
  s_mul_i32 s44, s76, 20480
  s_add_u32 s46, s44, 15728640
  v_lshlrev_b32 v7, 4, v1
  s_add_u32 s45, s46, 0
  buffer_load_dwordx4 v[128:131], v7, s[24:27], s45 offen offset:0
  s_add_u32 s45, s46, 20480
  buffer_load_dwordx4 v[132:135], v7, s[24:27], s45 offen offset:0
  s_add_u32 s45, s46, 0
  buffer_load_dwordx4 v[136:139], v7, s[24:27], s45 offen offset:1024
  s_add_u32 s45, s46, 20480
  buffer_load_dwordx4 v[140:143], v7, s[24:27], s45 offen offset:1024
  s_add_u32 s45, s46, 0
  buffer_load_dwordx4 v[144:147], v7, s[24:27], s45 offen offset:2048
  s_add_u32 s45, s46, 20480
  buffer_load_dwordx4 v[148:151], v7, s[24:27], s45 offen offset:2048
  s_add_u32 s45, s46, 0
  buffer_load_dwordx4 v[152:155], v7, s[24:27], s45 offen offset:3072
  s_add_u32 s45, s46, 20480
  buffer_load_dwordx4 v[156:159], v7, s[24:27], s45 offen offset:3072
  s_add_u32 s45, s46, 4096
  buffer_load_dwordx4 v[160:163], v7, s[24:27], s45 offen offset:0
  s_add_u32 s45, s46, 24576
  buffer_load_dwordx4 v[164:167], v7, s[24:27], s45 offen offset:0
  s_add_u32 s45, s46, 4096
  buffer_load_dwordx4 v[168:171], v7, s[24:27], s45 offen offset:1024
  s_add_u32 s45, s46, 24576
  buffer_load_dwordx4 v[172:175], v7, s[24:27], s45 offen offset:1024
  s_add_u32 s45, s46, 4096
  buffer_load_dwordx4 v[176:179], v7, s[24:27], s45 offen offset:2048
  s_add_u32 s45, s46, 24576
  buffer_load_dwordx4 v[180:183], v7, s[24:27], s45 offen offset:2048
  s_add_u32 s45, s46, 4096
  buffer_load_dwordx4 v[184:187], v7, s[24:27], s45 offen offset:3072
  s_add_u32 s45, s46, 24576
  buffer_load_dwordx4 v[188:191], v7, s[24:27], s45 offen offset:3072
  v_mov_b32 v16, 0
  v_mov_b32 v17, 0
  v_mov_b32 v18, 0
  v_mov_b32 v19, 0
  v_mov_b32 v20, 0
  v_mov_b32 v21, 0
  v_mov_b32 v22, 0
  v_mov_b32 v23, 0
  v_mov_b32 v24, 0
  v_mov_b32 v25, 0
  v_mov_b32 v26, 0
  v_mov_b32 v27, 0
  v_mov_b32 v28, 0
  v_mov_b32 v29, 0
  v_mov_b32 v30, 0
  v_mov_b32 v31, 0
  v_mov_b32 v32, 0
  v_mov_b32 v33, 0
  v_mov_b32 v34, 0
  v_mov_b32 v35, 0
  v_mov_b32 v36, 0
  v_mov_b32 v37, 0
  v_mov_b32 v38, 0
  v_mov_b32 v39, 0
  v_mov_b32 v40, 0
  v_mov_b32 v41, 0
  v_mov_b32 v42, 0
  v_mov_b32 v43, 0
  v_mov_b32 v44, 0
  v_mov_b32 v45, 0
  v_mov_b32 v46, 0
  v_mov_b32 v47, 0
  v_mov_b32 v48, 0
  v_mov_b32 v49, 0
  v_mov_b32 v50, 0
  v_mov_b32 v51, 0
  v_mov_b32 v52, 0
  v_mov_b32 v53, 0
  v_mov_b32 v54, 0
  v_mov_b32 v55, 0
  v_mov_b32 v56, 0
  v_mov_b32 v57, 0
  v_mov_b32 v58, 0
  v_mov_b32 v59, 0
  v_mov_b32 v60, 0
  v_mov_b32 v61, 0
  v_mov_b32 v62, 0
  v_mov_b32 v63, 0
  v_mov_b32 v64, 0
  v_mov_b32 v65, 0
  v_mov_b32 v66, 0
  v_mov_b32 v67, 0
  v_mov_b32 v68, 0
  v_mov_b32 v69, 0
  v_mov_b32 v70, 0
  v_mov_b32 v71, 0
  v_mov_b32 v2, 0
  v_mov_b32 v3, 0
  v_mov_b32 v4, 0
  v_mov_b32 v5, 0
  s_waitcnt vmcnt(16)
  s_barrier
  ds_read_b64_tr_b16 v[72:73], v14 offset:0
  ds_read_b64_tr_b16 v[74:75], v14 offset:448
  ds_read_b64_tr_b16 v[76:77], v14 offset:16
  ds_read_b64_tr_b16 v[78:79], v14 offset:464
  ds_read_b64_tr_b16 v[80:81], v14 offset:32
  ds_read_b64_tr_b16 v[82:83], v14 offset:480
  ds_read_b64_tr_b16 v[84:85], v14 offset:48
  ds_read_b64_tr_b16 v[86:87], v14 offset:496
  ds_read_b64_tr_b16 v[88:89], v14 offset:64
  ds_read_b64_tr_b16 v[90:91], v14 offset:512
  ds_read_b64_tr_b16 v[92:93], v14 offset:80
  ds_read_b64_tr_b16 v[94:95], v14 offset:528
  ds_read_b64_tr_b16 v[96:97], v14 offset:96
  ds_read_b64_tr_b16 v[98:99], v14 offset:544
  ds_read_b64_tr_b16 v[200:201], v9 offset:0
  ds_read_b64_tr_b16 v[202:203], v9 offset:448
  ds_read_b128 v[192:195], v6 offset:0
  s_waitcnt lgkmcnt(0)
  s_waitcnt vmcnt(14)
  v_mfma_f32_16x16x32_bf16 v[16:19], v[72:75], v[128:131], v[16:19]
  ds_read_b64_tr_b16 v[100:101], v14 offset:3840
  ds_read_b64_tr_b16 v[102:103], v14 offset:4288
  v_mfma_f32_16x16x32_bf16 v[20:23], v[72:75], v[132:135], v[20:23]
  ds_read_b64_tr_b16 v[104:105], v14 offset:3856
  ds_read_b64_tr_b16 v[106:107], v14 offset:4304
  v_mfma_f32_16x16x32_bf16 v[24:27], v[76:79], v[128:131], v[24:27]
  ds_read_b64_tr_b16 v[108:109], v14 offset:3872
  ds_read_b64_tr_b16 v[110:111], v14 offset:4320
  v_mfma_f32_16x16x32_bf16 v[28:31], v[76:79], v[132:135], v[28:31]
  ds_read_b64_tr_b16 v[112:113], v14 offset:3888
  ds_read_b64_tr_b16 v[114:115], v14 offset:4336
  v_mfma_f32_16x16x32_bf16 v[32:35], v[80:83], v[128:131], v[32:35]
  ds_read_b64_tr_b16 v[116:117], v14 offset:3904
  ds_read_b64_tr_b16 v[118:119], v14 offset:4352
  v_mfma_f32_16x16x32_bf16 v[36:39], v[80:83], v[132:135], v[36:39]
  ds_read_b64_tr_b16 v[120:121], v14 offset:3920
  ds_read_b64_tr_b16 v[122:123], v14 offset:4368
  v_mfma_f32_16x16x32_bf16 v[40:43], v[84:87], v[128:131], v[40:43]
  ds_read_b64_tr_b16 v[124:125], v14 offset:3936
  ds_read_b64_tr_b16 v[126:127], v14 offset:4384
  v_mfma_f32_16x16x32_bf16 v[44:47], v[84:87], v[132:135], v[44:47]
  ds_read_b64_tr_b16 v[204:205], v9 offset:3840
  ds_read_b64_tr_b16 v[206:207], v9 offset:4288
  v_mfma_f32_16x16x32_bf16 v[48:51], v[88:91], v[128:131], v[48:51]
  ds_read_b128 v[196:199], v6 offset:64
  v_mfma_f32_16x16x32_bf16 v[52:55], v[88:91], v[132:135], v[52:55]
  v_mfma_f32_16x16x32_bf16 v[2:5], v[200:203], v[192:195], v[2:5]
  v_mfma_f32_16x16x32_bf16 v[56:59], v[92:95], v[128:131], v[56:59]
  v_mfma_f32_16x16x32_bf16 v[60:63], v[92:95], v[132:135], v[60:63]
  v_mfma_f32_16x16x32_bf16 v[64:67], v[96:99], v[128:131], v[64:67]
  v_mfma_f32_16x16x32_bf16 v[68:71], v[96:99], v[132:135], v[68:71]
  s_waitcnt lgkmcnt(0)
  s_waitcnt vmcnt(12)
  v_mfma_f32_16x16x32_bf16 v[16:19], v[100:103], v[136:139], v[16:19]
  ds_read_b64_tr_b16 v[72:73], v14 offset:7680
  ds_read_b64_tr_b16 v[74:75], v14 offset:8128
  v_mfma_f32_16x16x32_bf16 v[20:23], v[100:103], v[140:143], v[20:23]
  ds_read_b64_tr_b16 v[76:77], v14 offset:7696
  ds_read_b64_tr_b16 v[78:79], v14 offset:8144
  v_mfma_f32_16x16x32_bf16 v[24:27], v[104:107], v[136:139], v[24:27]
  ds_read_b64_tr_b16 v[80:81], v14 offset:7712
  ds_read_b64_tr_b16 v[82:83], v14 offset:8160
  v_mfma_f32_16x16x32_bf16 v[28:31], v[104:107], v[140:143], v[28:31]
  ds_read_b64_tr_b16 v[84:85], v14 offset:7728
  ds_read_b64_tr_b16 v[86:87], v14 offset:8176
  v_mfma_f32_16x16x32_bf16 v[32:35], v[108:111], v[136:139], v[32:35]
  ds_read_b64_tr_b16 v[88:89], v14 offset:7744
  ds_read_b64_tr_b16 v[90:91], v14 offset:8192
  v_mfma_f32_16x16x32_bf16 v[36:39], v[108:111], v[140:143], v[36:39]
  ds_read_b64_tr_b16 v[92:93], v14 offset:7760
  ds_read_b64_tr_b16 v[94:95], v14 offset:8208
  v_mfma_f32_16x16x32_bf16 v[40:43], v[112:115], v[136:139], v[40:43]
  ds_read_b64_tr_b16 v[96:97], v14 offset:7776
  ds_read_b64_tr_b16 v[98:99], v14 offset:8224
  v_mfma_f32_16x16x32_bf16 v[44:47], v[112:115], v[140:143], v[44:47]
  ds_read_b64_tr_b16 v[200:201], v9 offset:7680
  ds_read_b64_tr_b16 v[202:203], v9 offset:8128
  v_mfma_f32_16x16x32_bf16 v[48:51], v[116:119], v[136:139], v[48:51]
  ds_read_b128 v[192:195], v6 offset:128
  v_mfma_f32_16x16x32_bf16 v[52:55], v[116:119], v[140:143], v[52:55]
  s_add_u32 s45, s46, 8192
  buffer_load_dwordx4 v[128:131], v7, s[24:27], s45 offen offset:0
  v_mfma_f32_16x16x32_bf16 v[2:5], v[204:207], v[196:199], v[2:5]
  s_add_u32 s45, s46, 28672
  buffer_load_dwordx4 v[132:135], v7, s[24:27], s45 offen offset:0
  v_mfma_f32_16x16x32_bf16 v[56:59], v[120:123], v[136:139], v[56:59]
  v_mfma_f32_16x16x32_bf16 v[60:63], v[120:123], v[140:143], v[60:63]
  v_mfma_f32_16x16x32_bf16 v[64:67], v[124:127], v[136:139], v[64:67]
  v_mfma_f32_16x16x32_bf16 v[68:71], v[124:127], v[140:143], v[68:71]
  s_waitcnt lgkmcnt(0)
  s_waitcnt vmcnt(12)
  v_mfma_f32_16x16x32_bf16 v[16:19], v[72:75], v[144:147], v[16:19]
  ds_read_b64_tr_b16 v[100:101], v14 offset:11520
  ds_read_b64_tr_b16 v[102:103], v14 offset:11968
  v_mfma_f32_16x16x32_bf16 v[20:23], v[72:75], v[148:151], v[20:23]
  ds_read_b64_tr_b16 v[104:105], v14 offset:11536
  ds_read_b64_tr_b16 v[106:107], v14 offset:11984
  v_mfma_f32_16x16x32_bf16 v[24:27], v[76:79], v[144:147], v[24:27]
  ds_read_b64_tr_b16 v[108:109], v14 offset:11552
  ds_read_b64_tr_b16 v[110:111], v14 offset:12000
  v_mfma_f32_16x16x32_bf16 v[28:31], v[76:79], v[148:151], v[28:31]
  ds_read_b64_tr_b16 v[112:113], v14 offset:11568
  ds_read_b64_tr_b16 v[114:115], v14 offset:12016
  v_mfma_f32_16x16x32_bf16 v[32:35], v[80:83], v[144:147], v[32:35]
  ds_read_b64_tr_b16 v[116:117], v14 offset:11584
  ds_read_b64_tr_b16 v[118:119], v14 offset:12032
  v_mfma_f32_16x16x32_bf16 v[36:39], v[80:83], v[148:151], v[36:39]
  ds_read_b64_tr_b16 v[120:121], v14 offset:11600
  ds_read_b64_tr_b16 v[122:123], v14 offset:12048
  v_mfma_f32_16x16x32_bf16 v[40:43], v[84:87], v[144:147], v[40:43]
  ds_read_b64_tr_b16 v[124:125], v14 offset:11616
  ds_read_b64_tr_b16 v[126:127], v14 offset:12064
  v_mfma_f32_16x16x32_bf16 v[44:47], v[84:87], v[148:151], v[44:47]
  ds_read_b64_tr_b16 v[204:205], v9 offset:11520
  ds_read_b64_tr_b16 v[206:207], v9 offset:11968
  v_mfma_f32_16x16x32_bf16 v[48:51], v[88:91], v[144:147], v[48:51]
  ds_read_b128 v[196:199], v6 offset:192
  v_mfma_f32_16x16x32_bf16 v[52:55], v[88:91], v[148:151], v[52:55]
  s_add_u32 s45, s46, 8192
  buffer_load_dwordx4 v[136:139], v7, s[24:27], s45 offen offset:1024
  v_mfma_f32_16x16x32_bf16 v[2:5], v[200:203], v[192:195], v[2:5]
  s_add_u32 s45, s46, 28672
  buffer_load_dwordx4 v[140:143], v7, s[24:27], s45 offen offset:1024
  v_mfma_f32_16x16x32_bf16 v[56:59], v[92:95], v[144:147], v[56:59]
  v_mfma_f32_16x16x32_bf16 v[60:63], v[92:95], v[148:151], v[60:63]
  v_mfma_f32_16x16x32_bf16 v[64:67], v[96:99], v[144:147], v[64:67]
  v_mfma_f32_16x16x32_bf16 v[68:71], v[96:99], v[148:151], v[68:71]
  s_waitcnt lgkmcnt(0)
  s_waitcnt vmcnt(12)
  v_mfma_f32_16x16x32_bf16 v[16:19], v[100:103], v[152:155], v[16:19]
  ds_read_b64_tr_b16 v[72:73], v14 offset:15360
  ds_read_b64_tr_b16 v[74:75], v14 offset:15808
  v_mfma_f32_16x16x32_bf16 v[20:23], v[100:103], v[156:159], v[20:23]
  ds_read_b64_tr_b16 v[76:77], v14 offset:15376
  ds_read_b64_tr_b16 v[78:79], v14 offset:15824
  v_mfma_f32_16x16x32_bf16 v[24:27], v[104:107], v[152:155], v[24:27]
  ds_read_b64_tr_b16 v[80:81], v14 offset:15392
  ds_read_b64_tr_b16 v[82:83], v14 offset:15840
  v_mfma_f32_16x16x32_bf16 v[28:31], v[104:107], v[156:159], v[28:31]
  ds_read_b64_tr_b16 v[84:85], v14 offset:15408
  ds_read_b64_tr_b16 v[86:87], v14 offset:15856
  v_mfma_f32_16x16x32_bf16 v[32:35], v[108:111], v[152:155], v[32:35]
  ds_read_b64_tr_b16 v[88:89], v14 offset:15424
  ds_read_b64_tr_b16 v[90:91], v14 offset:15872
  v_mfma_f32_16x16x32_bf16 v[36:39], v[108:111], v[156:159], v[36:39]
  ds_read_b64_tr_b16 v[92:93], v14 offset:15440
  ds_read_b64_tr_b16 v[94:95], v14 offset:15888
  v_mfma_f32_16x16x32_bf16 v[40:43], v[112:115], v[152:155], v[40:43]
  ds_read_b64_tr_b16 v[96:97], v14 offset:15456
  ds_read_b64_tr_b16 v[98:99], v14 offset:15904
  v_mfma_f32_16x16x32_bf16 v[44:47], v[112:115], v[156:159], v[44:47]
  ds_read_b64_tr_b16 v[200:201], v9 offset:15360
  ds_read_b64_tr_b16 v[202:203], v9 offset:15808
  v_mfma_f32_16x16x32_bf16 v[48:51], v[116:119], v[152:155], v[48:51]
  ds_read_b128 v[192:195], v6 offset:256
  v_mfma_f32_16x16x32_bf16 v[52:55], v[116:119], v[156:159], v[52:55]
  s_add_u32 s45, s46, 8192
  buffer_load_dwordx4 v[144:147], v7, s[24:27], s45 offen offset:2048
  v_mfma_f32_16x16x32_bf16 v[2:5], v[204:207], v[196:199], v[2:5]
  s_add_u32 s45, s46, 28672
  buffer_load_dwordx4 v[148:151], v7, s[24:27], s45 offen offset:2048
  v_mfma_f32_16x16x32_bf16 v[56:59], v[120:123], v[152:155], v[56:59]
  v_mfma_f32_16x16x32_bf16 v[60:63], v[120:123], v[156:159], v[60:63]
  v_mfma_f32_16x16x32_bf16 v[64:67], v[124:127], v[152:155], v[64:67]
  v_mfma_f32_16x16x32_bf16 v[68:71], v[124:127], v[156:159], v[68:71]
  s_waitcnt lgkmcnt(0)
  s_waitcnt vmcnt(12)
  v_mfma_f32_16x16x32_bf16 v[16:19], v[72:75], v[160:163], v[16:19]
  ds_read_b64_tr_b16 v[100:101], v14 offset:19200
  ds_read_b64_tr_b16 v[102:103], v14 offset:19648
  v_mfma_f32_16x16x32_bf16 v[20:23], v[72:75], v[164:167], v[20:23]
  ds_read_b64_tr_b16 v[104:105], v14 offset:19216
  ds_read_b64_tr_b16 v[106:107], v14 offset:19664
  v_mfma_f32_16x16x32_bf16 v[24:27], v[76:79], v[160:163], v[24:27]
  ds_read_b64_tr_b16 v[108:109], v14 offset:19232
  ds_read_b64_tr_b16 v[110:111], v14 offset:19680
  v_mfma_f32_16x16x32_bf16 v[28:31], v[76:79], v[164:167], v[28:31]
  ds_read_b64_tr_b16 v[112:113], v14 offset:19248
  ds_read_b64_tr_b16 v[114:115], v14 offset:19696
  v_mfma_f32_16x16x32_bf16 v[32:35], v[80:83], v[160:163], v[32:35]
  ds_read_b64_tr_b16 v[116:117], v14 offset:19264
  ds_read_b64_tr_b16 v[118:119], v14 offset:19712
  v_mfma_f32_16x16x32_bf16 v[36:39], v[80:83], v[164:167], v[36:39]
  ds_read_b64_tr_b16 v[120:121], v14 offset:19280
  ds_read_b64_tr_b16 v[122:123], v14 offset:19728
  v_mfma_f32_16x16x32_bf16 v[40:43], v[84:87], v[160:163], v[40:43]
  ds_read_b64_tr_b16 v[124:125], v14 offset:19296
  ds_read_b64_tr_b16 v[126:127], v14 offset:19744
  v_mfma_f32_16x16x32_bf16 v[44:47], v[84:87], v[164:167], v[44:47]
  ds_read_b64_tr_b16 v[204:205], v9 offset:19200
  ds_read_b64_tr_b16 v[206:207], v9 offset:19648
  v_mfma_f32_16x16x32_bf16 v[48:51], v[88:91], v[160:163], v[48:51]
  ds_read_b128 v[196:199], v6 offset:320
  v_mfma_f32_16x16x32_bf16 v[52:55], v[88:91], v[164:167], v[52:55]
  s_add_u32 s45, s46, 8192
  buffer_load_dwordx4 v[152:155], v7, s[24:27], s45 offen offset:3072
  v_mfma_f32_16x16x32_bf16 v[2:5], v[200:203], v[192:195], v[2:5]
  s_add_u32 s45, s46, 28672
  buffer_load_dwordx4 v[156:159], v7, s[24:27], s45 offen offset:3072
  v_mfma_f32_16x16x32_bf16 v[56:59], v[92:95], v[160:163], v[56:59]
  v_mfma_f32_16x16x32_bf16 v[60:63], v[92:95], v[164:167], v[60:63]
  v_mfma_f32_16x16x32_bf16 v[64:67], v[96:99], v[160:163], v[64:67]
  v_mfma_f32_16x16x32_bf16 v[68:71], v[96:99], v[164:167], v[68:71]
  s_waitcnt lgkmcnt(0)
  s_waitcnt vmcnt(12)
  v_mfma_f32_16x16x32_bf16 v[16:19], v[100:103], v[168:171], v[16:19]
  ds_read_b64_tr_b16 v[72:73], v14 offset:23040
  ds_read_b64_tr_b16 v[74:75], v14 offset:23488
  v_mfma_f32_16x16x32_bf16 v[20:23], v[100:103], v[172:175], v[20:23]
  ds_read_b64_tr_b16 v[76:77], v14 offset:23056
  ds_read_b64_tr_b16 v[78:79], v14 offset:23504
  v_mfma_f32_16x16x32_bf16 v[24:27], v[104:107], v[168:171], v[24:27]
  ds_read_b64_tr_b16 v[80:81], v14 offset:23072
  ds_read_b64_tr_b16 v[82:83], v14 offset:23520
  v_mfma_f32_16x16x32_bf16 v[28:31], v[104:107], v[172:175], v[28:31]
  ds_read_b64_tr_b16 v[84:85], v14 offset:23088
  ds_read_b64_tr_b16 v[86:87], v14 offset:23536
  v_mfma_f32_16x16x32_bf16 v[32:35], v[108:111], v[168:171], v[32:35]
  ds_read_b64_tr_b16 v[88:89], v14 offset:23104
  ds_read_b64_tr_b16 v[90:91], v14 offset:23552
  v_mfma_f32_16x16x32_bf16 v[36:39], v[108:111], v[172:175], v[36:39]
  ds_read_b64_tr_b16 v[92:93], v14 offset:23120
  ds_read_b64_tr_b16 v[94:95], v14 offset:23568
  v_mfma_f32_16x16x32_bf16 v[40:43], v[112:115], v[168:171], v[40:43]
  ds_read_b64_tr_b16 v[96:97], v14 offset:23136
  ds_read_b64_tr_b16 v[98:99], v14 offset:23584
  v_mfma_f32_16x16x32_bf16 v[44:47], v[112:115], v[172:175], v[44:47]
  ds_read_b64_tr_b16 v[200:201], v9 offset:23040
  ds_read_b64_tr_b16 v[202:203], v9 offset:23488
  v_mfma_f32_16x16x32_bf16 v[48:51], v[116:119], v[168:171], v[48:51]
  ds_read_b128 v[192:195], v6 offset:384
  v_mfma_f32_16x16x32_bf16 v[52:55], v[116:119], v[172:175], v[52:55]
  s_add_u32 s45, s46, 12288
  buffer_load_dwordx4 v[160:163], v7, s[24:27], s45 offen offset:0
  v_mfma_f32_16x16x32_bf16 v[2:5], v[204:207], v[196:199], v[2:5]
  s_add_u32 s45, s46, 32768
  buffer_load_dwordx4 v[164:167], v7, s[24:27], s45 offen offset:0
  v_mfma_f32_16x16x32_bf16 v[56:59], v[120:123], v[168:171], v[56:59]
  v_mfma_f32_16x16x32_bf16 v[60:63], v[120:123], v[172:175], v[60:63]
  v_mfma_f32_16x16x32_bf16 v[64:67], v[124:127], v[168:171], v[64:67]
  v_mfma_f32_16x16x32_bf16 v[68:71], v[124:127], v[172:175], v[68:71]
  s_waitcnt lgkmcnt(0)
  s_waitcnt vmcnt(12)
  v_mfma_f32_16x16x32_bf16 v[16:19], v[72:75], v[176:179], v[16:19]
  ds_read_b64_tr_b16 v[100:101], v14 offset:26880
  ds_read_b64_tr_b16 v[102:103], v14 offset:27328
  v_mfma_f32_16x16x32_bf16 v[20:23], v[72:75], v[180:183], v[20:23]
  ds_read_b64_tr_b16 v[104:105], v14 offset:26896
  ds_read_b64_tr_b16 v[106:107], v14 offset:27344
  v_mfma_f32_16x16x32_bf16 v[24:27], v[76:79], v[176:179], v[24:27]
  ds_read_b64_tr_b16 v[108:109], v14 offset:26912
  ds_read_b64_tr_b16 v[110:111], v14 offset:27360
  v_mfma_f32_16x16x32_bf16 v[28:31], v[76:79], v[180:183], v[28:31]
  ds_read_b64_tr_b16 v[112:113], v14 offset:26928
  ds_read_b64_tr_b16 v[114:115], v14 offset:27376
  v_mfma_f32_16x16x32_bf16 v[32:35], v[80:83], v[176:179], v[32:35]
  ds_read_b64_tr_b16 v[116:117], v14 offset:26944
  ds_read_b64_tr_b16 v[118:119], v14 offset:27392
  v_mfma_f32_16x16x32_bf16 v[36:39], v[80:83], v[180:183], v[36:39]
  ds_read_b64_tr_b16 v[120:121], v14 offset:26960
  ds_read_b64_tr_b16 v[122:123], v14 offset:27408
  v_mfma_f32_16x16x32_bf16 v[40:43], v[84:87], v[176:179], v[40:43]
  ds_read_b64_tr_b16 v[124:125], v14 offset:26976
  ds_read_b64_tr_b16 v[126:127], v14 offset:27424
  v_mfma_f32_16x16x32_bf16 v[44:47], v[84:87], v[180:183], v[44:47]
  ds_read_b64_tr_b16 v[204:205], v9 offset:26880
  ds_read_b64_tr_b16 v[206:207], v9 offset:27328
  v_mfma_f32_16x16x32_bf16 v[48:51], v[88:91], v[176:179], v[48:51]
  ds_read_b128 v[196:199], v6 offset:448
  v_mfma_f32_16x16x32_bf16 v[52:55], v[88:91], v[180:183], v[52:55]
  s_add_u32 s45, s46, 12288
  buffer_load_dwordx4 v[168:171], v7, s[24:27], s45 offen offset:1024
  v_mfma_f32_16x16x32_bf16 v[2:5], v[200:203], v[192:195], v[2:5]
  s_add_u32 s45, s46, 32768
  buffer_load_dwordx4 v[172:175], v7, s[24:27], s45 offen offset:1024
  v_mfma_f32_16x16x32_bf16 v[56:59], v[92:95], v[176:179], v[56:59]
  v_mfma_f32_16x16x32_bf16 v[60:63], v[92:95], v[180:183], v[60:63]
  v_mfma_f32_16x16x32_bf16 v[64:67], v[96:99], v[176:179], v[64:67]
  v_mfma_f32_16x16x32_bf16 v[68:71], v[96:99], v[180:183], v[68:71]
  s_waitcnt lgkmcnt(0)
  s_waitcnt vmcnt(12)
  v_mfma_f32_16x16x32_bf16 v[16:19], v[100:103], v[184:187], v[16:19]
  ds_read_b64_tr_b16 v[72:73], v14 offset:30720
  ds_read_b64_tr_b16 v[74:75], v14 offset:31168
  v_mfma_f32_16x16x32_bf16 v[20:23], v[100:103], v[188:191], v[20:23]
  ds_read_b64_tr_b16 v[76:77], v14 offset:30736
  ds_read_b64_tr_b16 v[78:79], v14 offset:31184
  v_mfma_f32_16x16x32_bf16 v[24:27], v[104:107], v[184:187], v[24:27]
  ds_read_b64_tr_b16 v[80:81], v14 offset:30752
  ds_read_b64_tr_b16 v[82:83], v14 offset:31200
  v_mfma_f32_16x16x32_bf16 v[28:31], v[104:107], v[188:191], v[28:31]
  ds_read_b64_tr_b16 v[84:85], v14 offset:30768
  ds_read_b64_tr_b16 v[86:87], v14 offset:31216
  v_mfma_f32_16x16x32_bf16 v[32:35], v[108:111], v[184:187], v[32:35]
  ds_read_b64_tr_b16 v[88:89], v14 offset:30784
  ds_read_b64_tr_b16 v[90:91], v14 offset:31232
  v_mfma_f32_16x16x32_bf16 v[36:39], v[108:111], v[188:191], v[36:39]
  ds_read_b64_tr_b16 v[92:93], v14 offset:30800
  ds_read_b64_tr_b16 v[94:95], v14 offset:31248
  v_mfma_f32_16x16x32_bf16 v[40:43], v[112:115], v[184:187], v[40:43]
  ds_read_b64_tr_b16 v[96:97], v14 offset:30816
  ds_read_b64_tr_b16 v[98:99], v14 offset:31264
  v_mfma_f32_16x16x32_bf16 v[44:47], v[112:115], v[188:191], v[44:47]
  ds_read_b64_tr_b16 v[200:201], v9 offset:30720
  ds_read_b64_tr_b16 v[202:203], v9 offset:31168
  v_mfma_f32_16x16x32_bf16 v[48:51], v[116:119], v[184:187], v[48:51]
  ds_read_b128 v[192:195], v6 offset:512
  v_mfma_f32_16x16x32_bf16 v[52:55], v[116:119], v[188:191], v[52:55]
  s_add_u32 s45, s46, 12288
  buffer_load_dwordx4 v[176:179], v7, s[24:27], s45 offen offset:2048
  v_mfma_f32_16x16x32_bf16 v[2:5], v[204:207], v[196:199], v[2:5]
  s_add_u32 s45, s46, 32768
  buffer_load_dwordx4 v[180:183], v7, s[24:27], s45 offen offset:2048
  v_mfma_f32_16x16x32_bf16 v[56:59], v[120:123], v[184:187], v[56:59]
  v_mfma_f32_16x16x32_bf16 v[60:63], v[120:123], v[188:191], v[60:63]
  v_mfma_f32_16x16x32_bf16 v[64:67], v[124:127], v[184:187], v[64:67]
  v_mfma_f32_16x16x32_bf16 v[68:71], v[124:127], v[188:191], v[68:71]
  s_waitcnt lgkmcnt(0)
  s_waitcnt vmcnt(12)
  v_mfma_f32_16x16x32_bf16 v[16:19], v[72:75], v[128:131], v[16:19]
  ds_read_b64_tr_b16 v[100:101], v14 offset:34560
  ds_read_b64_tr_b16 v[102:103], v14 offset:35008
  v_mfma_f32_16x16x32_bf16 v[20:23], v[72:75], v[132:135], v[20:23]
  ds_read_b64_tr_b16 v[104:105], v14 offset:34576
  ds_read_b64_tr_b16 v[106:107], v14 offset:35024
  v_mfma_f32_16x16x32_bf16 v[24:27], v[76:79], v[128:131], v[24:27]
  ds_read_b64_tr_b16 v[108:109], v14 offset:34592
  ds_read_b64_tr_b16 v[110:111], v14 offset:35040
  v_mfma_f32_16x16x32_bf16 v[28:31], v[76:79], v[132:135], v[28:31]
  ds_read_b64_tr_b16 v[112:113], v14 offset:34608
  ds_read_b64_tr_b16 v[114:115], v14 offset:35056
  v_mfma_f32_16x16x32_bf16 v[32:35], v[80:83], v[128:131], v[32:35]
  ds_read_b64_tr_b16 v[116:117], v14 offset:34624
  ds_read_b64_tr_b16 v[118:119], v14 offset:35072
  v_mfma_f32_16x16x32_bf16 v[36:39], v[80:83], v[132:135], v[36:39]
  ds_read_b64_tr_b16 v[120:121], v14 offset:34640
  ds_read_b64_tr_b16 v[122:123], v14 offset:35088
  v_mfma_f32_16x16x32_bf16 v[40:43], v[84:87], v[128:131], v[40:43]
  ds_read_b64_tr_b16 v[124:125], v14 offset:34656
  ds_read_b64_tr_b16 v[126:127], v14 offset:35104
  v_mfma_f32_16x16x32_bf16 v[44:47], v[84:87], v[132:135], v[44:47]
  ds_read_b64_tr_b16 v[204:205], v9 offset:34560
  ds_read_b64_tr_b16 v[206:207], v9 offset:35008
  v_mfma_f32_16x16x32_bf16 v[48:51], v[88:91], v[128:131], v[48:51]
  ds_read_b128 v[196:199], v6 offset:576
  v_mfma_f32_16x16x32_bf16 v[52:55], v[88:91], v[132:135], v[52:55]
  s_add_u32 s45, s46, 12288
  buffer_load_dwordx4 v[184:187], v7, s[24:27], s45 offen offset:3072
  v_mfma_f32_16x16x32_bf16 v[2:5], v[200:203], v[192:195], v[2:5]
  s_add_u32 s45, s46, 32768
  buffer_load_dwordx4 v[188:191], v7, s[24:27], s45 offen offset:3072
  v_mfma_f32_16x16x32_bf16 v[56:59], v[92:95], v[128:131], v[56:59]
  v_mfma_f32_16x16x32_bf16 v[60:63], v[92:95], v[132:135], v[60:63]
  v_mfma_f32_16x16x32_bf16 v[64:67], v[96:99], v[128:131], v[64:67]
  v_mfma_f32_16x16x32_bf16 v[68:71], v[96:99], v[132:135], v[68:71]
  s_waitcnt lgkmcnt(0)
  s_waitcnt vmcnt(12)
  v_mfma_f32_16x16x32_bf16 v[16:19], v[100:103], v[136:139], v[16:19]
  ds_read_b64_tr_b16 v[72:73], v15 offset:0
  ds_read_b64_tr_b16 v[74:75], v15 offset:448
  v_mfma_f32_16x16x32_bf16 v[20:23], v[100:103], v[140:143], v[20:23]
  ds_read_b64_tr_b16 v[76:77], v15 offset:16
  ds_read_b64_tr_b16 v[78:79], v15 offset:464
  v_mfma_f32_16x16x32_bf16 v[24:27], v[104:107], v[136:139], v[24:27]
  ds_read_b64_tr_b16 v[80:81], v15 offset:32
  ds_read_b64_tr_b16 v[82:83], v15 offset:480
  v_mfma_f32_16x16x32_bf16 v[28:31], v[104:107], v[140:143], v[28:31]
  ds_read_b64_tr_b16 v[84:85], v15 offset:48
  ds_read_b64_tr_b16 v[86:87], v15 offset:496
  v_mfma_f32_16x16x32_bf16 v[32:35], v[108:111], v[136:139], v[32:35]
  ds_read_b64_tr_b16 v[88:89], v15 offset:64
  ds_read_b64_tr_b16 v[90:91], v15 offset:512
  v_mfma_f32_16x16x32_bf16 v[36:39], v[108:111], v[140:143], v[36:39]
  ds_read_b64_tr_b16 v[92:93], v15 offset:80
  ds_read_b64_tr_b16 v[94:95], v15 offset:528
  v_mfma_f32_16x16x32_bf16 v[40:43], v[112:115], v[136:139], v[40:43]
  ds_read_b64_tr_b16 v[96:97], v15 offset:96
  ds_read_b64_tr_b16 v[98:99], v15 offset:544
  v_mfma_f32_16x16x32_bf16 v[44:47], v[112:115], v[140:143], v[44:47]
  ds_read_b64_tr_b16 v[200:201], v10 offset:0
  ds_read_b64_tr_b16 v[202:203], v10 offset:448
  v_mfma_f32_16x16x32_bf16 v[48:51], v[116:119], v[136:139], v[48:51]
  ds_read_b128 v[192:195], v6 offset:640
  v_mfma_f32_16x16x32_bf16 v[52:55], v[116:119], v[140:143], v[52:55]
  s_add_u32 s45, s46, 16384
  buffer_load_dwordx4 v[128:131], v7, s[24:27], s45 offen offset:0
  v_mfma_f32_16x16x32_bf16 v[2:5], v[204:207], v[196:199], v[2:5]
  s_add_u32 s45, s46, 36864
  buffer_load_dwordx4 v[132:135], v7, s[24:27], s45 offen offset:0
  v_mfma_f32_16x16x32_bf16 v[56:59], v[120:123], v[136:139], v[56:59]
  v_mfma_f32_16x16x32_bf16 v[60:63], v[120:123], v[140:143], v[60:63]
  v_mfma_f32_16x16x32_bf16 v[64:67], v[124:127], v[136:139], v[64:67]
  v_mfma_f32_16x16x32_bf16 v[68:71], v[124:127], v[140:143], v[68:71]
  s_waitcnt lgkmcnt(0)
  s_waitcnt vmcnt(12)
  v_mfma_f32_16x16x32_bf16 v[16:19], v[72:75], v[144:147], v[16:19]
  ds_read_b64_tr_b16 v[100:101], v15 offset:3840
  ds_read_b64_tr_b16 v[102:103], v15 offset:4288
  v_mfma_f32_16x16x32_bf16 v[20:23], v[72:75], v[148:151], v[20:23]
  ds_read_b64_tr_b16 v[104:105], v15 offset:3856
  ds_read_b64_tr_b16 v[106:107], v15 offset:4304
  v_mfma_f32_16x16x32_bf16 v[24:27], v[76:79], v[144:147], v[24:27]
  ds_read_b64_tr_b16 v[108:109], v15 offset:3872
  ds_read_b64_tr_b16 v[110:111], v15 offset:4320
  v_mfma_f32_16x16x32_bf16 v[28:31], v[76:79], v[148:151], v[28:31]
  ds_read_b64_tr_b16 v[112:113], v15 offset:3888
  ds_read_b64_tr_b16 v[114:115], v15 offset:4336
  v_mfma_f32_16x16x32_bf16 v[32:35], v[80:83], v[144:147], v[32:35]
  ds_read_b64_tr_b16 v[116:117], v15 offset:3904
  ds_read_b64_tr_b16 v[118:119], v15 offset:4352
  v_mfma_f32_16x16x32_bf16 v[36:39], v[80:83], v[148:151], v[36:39]
  ds_read_b64_tr_b16 v[120:121], v15 offset:3920
  ds_read_b64_tr_b16 v[122:123], v15 offset:4368
  v_mfma_f32_16x16x32_bf16 v[40:43], v[84:87], v[144:147], v[40:43]
  ds_read_b64_tr_b16 v[124:125], v15 offset:3936
  ds_read_b64_tr_b16 v[126:127], v15 offset:4384
  v_mfma_f32_16x16x32_bf16 v[44:47], v[84:87], v[148:151], v[44:47]
  ds_read_b64_tr_b16 v[204:205], v10 offset:3840
  ds_read_b64_tr_b16 v[206:207], v10 offset:4288
  v_mfma_f32_16x16x32_bf16 v[48:51], v[88:91], v[144:147], v[48:51]
  ds_read_b128 v[196:199], v6 offset:704
  v_mfma_f32_16x16x32_bf16 v[52:55], v[88:91], v[148:151], v[52:55]
  s_add_u32 s45, s46, 16384
  buffer_load_dwordx4 v[136:139], v7, s[24:27], s45 offen offset:1024
  v_mfma_f32_16x16x32_bf16 v[2:5], v[200:203], v[192:195], v[2:5]
  s_add_u32 s45, s46, 36864
  buffer_load_dwordx4 v[140:143], v7, s[24:27], s45 offen offset:1024
  v_mfma_f32_16x16x32_bf16 v[56:59], v[92:95], v[144:147], v[56:59]
  v_mfma_f32_16x16x32_bf16 v[60:63], v[92:95], v[148:151], v[60:63]
  v_mfma_f32_16x16x32_bf16 v[64:67], v[96:99], v[144:147], v[64:67]
  v_mfma_f32_16x16x32_bf16 v[68:71], v[96:99], v[148:151], v[68:71]
  s_waitcnt lgkmcnt(0)
  s_waitcnt vmcnt(12)
  v_mfma_f32_16x16x32_bf16 v[16:19], v[100:103], v[152:155], v[16:19]
  ds_read_b64_tr_b16 v[72:73], v15 offset:7680
  ds_read_b64_tr_b16 v[74:75], v15 offset:8128
  v_mfma_f32_16x16x32_bf16 v[20:23], v[100:103], v[156:159], v[20:23]
  ds_read_b64_tr_b16 v[76:77], v15 offset:7696
  ds_read_b64_tr_b16 v[78:79], v15 offset:8144
  v_mfma_f32_16x16x32_bf16 v[24:27], v[104:107], v[152:155], v[24:27]
  ds_read_b64_tr_b16 v[80:81], v15 offset:7712
  ds_read_b64_tr_b16 v[82:83], v15 offset:8160
  v_mfma_f32_16x16x32_bf16 v[28:31], v[104:107], v[156:159], v[28:31]
  ds_read_b64_tr_b16 v[84:85], v15 offset:7728
  ds_read_b64_tr_b16 v[86:87], v15 offset:8176
  v_mfma_f32_16x16x32_bf16 v[32:35], v[108:111], v[152:155], v[32:35]
  ds_read_b64_tr_b16 v[88:89], v15 offset:7744
  ds_read_b64_tr_b16 v[90:91], v15 offset:8192
  v_mfma_f32_16x16x32_bf16 v[36:39], v[108:111], v[156:159], v[36:39]
  ds_read_b64_tr_b16 v[92:93], v15 offset:7760
  ds_read_b64_tr_b16 v[94:95], v15 offset:8208
  v_mfma_f32_16x16x32_bf16 v[40:43], v[112:115], v[152:155], v[40:43]
  ds_read_b64_tr_b16 v[96:97], v15 offset:7776
  ds_read_b64_tr_b16 v[98:99], v15 offset:8224
  v_mfma_f32_16x16x32_bf16 v[44:47], v[112:115], v[156:159], v[44:47]
  ds_read_b64_tr_b16 v[200:201], v10 offset:7680
  ds_read_b64_tr_b16 v[202:203], v10 offset:8128
  v_mfma_f32_16x16x32_bf16 v[48:51], v[116:119], v[152:155], v[48:51]
  ds_read_b128 v[192:195], v6 offset:768
  v_mfma_f32_16x16x32_bf16 v[52:55], v[116:119], v[156:159], v[52:55]
  s_add_u32 s45, s46, 16384
  buffer_load_dwordx4 v[144:147], v7, s[24:27], s45 offen offset:2048
  v_mfma_f32_16x16x32_bf16 v[2:5], v[204:207], v[196:199], v[2:5]
  s_add_u32 s45, s46, 36864
  buffer_load_dwordx4 v[148:151], v7, s[24:27], s45 offen offset:2048
  v_mfma_f32_16x16x32_bf16 v[56:59], v[120:123], v[152:155], v[56:59]
  v_mfma_f32_16x16x32_bf16 v[60:63], v[120:123], v[156:159], v[60:63]
  v_mfma_f32_16x16x32_bf16 v[64:67], v[124:127], v[152:155], v[64:67]
  v_mfma_f32_16x16x32_bf16 v[68:71], v[124:127], v[156:159], v[68:71]
  s_waitcnt lgkmcnt(0)
  s_waitcnt vmcnt(12)
  v_mfma_f32_16x16x32_bf16 v[16:19], v[72:75], v[160:163], v[16:19]
  ds_read_b64_tr_b16 v[100:101], v15 offset:11520
  ds_read_b64_tr_b16 v[102:103], v15 offset:11968
  v_mfma_f32_16x16x32_bf16 v[20:23], v[72:75], v[164:167], v[20:23]
  ds_read_b64_tr_b16 v[104:105], v15 offset:11536
  ds_read_b64_tr_b16 v[106:107], v15 offset:11984
  v_mfma_f32_16x16x32_bf16 v[24:27], v[76:79], v[160:163], v[24:27]
  ds_read_b64_tr_b16 v[108:109], v15 offset:11552
  ds_read_b64_tr_b16 v[110:111], v15 offset:12000
  v_mfma_f32_16x16x32_bf16 v[28:31], v[76:79], v[164:167], v[28:31]
  ds_read_b64_tr_b16 v[112:113], v15 offset:11568
  ds_read_b64_tr_b16 v[114:115], v15 offset:12016
  v_mfma_f32_16x16x32_bf16 v[32:35], v[80:83], v[160:163], v[32:35]
  ds_read_b64_tr_b16 v[116:117], v15 offset:11584
  ds_read_b64_tr_b16 v[118:119], v15 offset:12032
  v_mfma_f32_16x16x32_bf16 v[36:39], v[80:83], v[164:167], v[36:39]
  ds_read_b64_tr_b16 v[120:121], v15 offset:11600
  ds_read_b64_tr_b16 v[122:123], v15 offset:12048
  v_mfma_f32_16x16x32_bf16 v[40:43], v[84:87], v[160:163], v[40:43]
  ds_read_b64_tr_b16 v[124:125], v15 offset:11616
  ds_read_b64_tr_b16 v[126:127], v15 offset:12064
  v_mfma_f32_16x16x32_bf16 v[44:47], v[84:87], v[164:167], v[44:47]
  ds_read_b64_tr_b16 v[204:205], v10 offset:11520
  ds_read_b64_tr_b16 v[206:207], v10 offset:11968
  v_mfma_f32_16x16x32_bf16 v[48:51], v[88:91], v[160:163], v[48:51]
  ds_read_b128 v[196:199], v6 offset:832
  v_mfma_f32_16x16x32_bf16 v[52:55], v[88:91], v[164:167], v[52:55]
  s_add_u32 s45, s46, 16384
  buffer_load_dwordx4 v[152:155], v7, s[24:27], s45 offen offset:3072
  v_mfma_f32_16x16x32_bf16 v[2:5], v[200:203], v[192:195], v[2:5]
  s_add_u32 s45, s46, 36864
  buffer_load_dwordx4 v[156:159], v7, s[24:27], s45 offen offset:3072
  v_mfma_f32_16x16x32_bf16 v[56:59], v[92:95], v[160:163], v[56:59]
  v_mfma_f32_16x16x32_bf16 v[60:63], v[92:95], v[164:167], v[60:63]
  v_mfma_f32_16x16x32_bf16 v[64:67], v[96:99], v[160:163], v[64:67]
  v_mfma_f32_16x16x32_bf16 v[68:71], v[96:99], v[164:167], v[68:71]
  s_waitcnt lgkmcnt(0)
  s_waitcnt vmcnt(12)
  v_mfma_f32_16x16x32_bf16 v[16:19], v[100:103], v[168:171], v[16:19]
  ds_read_b64_tr_b16 v[72:73], v15 offset:15360
  ds_read_b64_tr_b16 v[74:75], v15 offset:15808
  v_mfma_f32_16x16x32_bf16 v[20:23], v[100:103], v[172:175], v[20:23]
  ds_read_b64_tr_b16 v[76:77], v15 offset:15376
  ds_read_b64_tr_b16 v[78:79], v15 offset:15824
  v_mfma_f32_16x16x32_bf16 v[24:27], v[104:107], v[168:171], v[24:27]
  ds_read_b64_tr_b16 v[80:81], v15 offset:15392
  ds_read_b64_tr_b16 v[82:83], v15 offset:15840
  v_mfma_f32_16x16x32_bf16 v[28:31], v[104:107], v[172:175], v[28:31]
  ds_read_b64_tr_b16 v[84:85], v15 offset:15408
  ds_read_b64_tr_b16 v[86:87], v15 offset:15856
  v_mfma_f32_16x16x32_bf16 v[32:35], v[108:111], v[168:171], v[32:35]
  ds_read_b64_tr_b16 v[88:89], v15 offset:15424
  ds_read_b64_tr_b16 v[90:91], v15 offset:15872
  v_mfma_f32_16x16x32_bf16 v[36:39], v[108:111], v[172:175], v[36:39]
  ds_read_b64_tr_b16 v[92:93], v15 offset:15440
  ds_read_b64_tr_b16 v[94:95], v15 offset:15888
  v_mfma_f32_16x16x32_bf16 v[40:43], v[112:115], v[168:171], v[40:43]
  ds_read_b64_tr_b16 v[96:97], v15 offset:15456
  ds_read_b64_tr_b16 v[98:99], v15 offset:15904
  v_mfma_f32_16x16x32_bf16 v[44:47], v[112:115], v[172:175], v[44:47]
  ds_read_b64_tr_b16 v[200:201], v10 offset:15360
  ds_read_b64_tr_b16 v[202:203], v10 offset:15808
  v_mfma_f32_16x16x32_bf16 v[48:51], v[116:119], v[168:171], v[48:51]
  ds_read_b128 v[192:195], v6 offset:896
  v_mfma_f32_16x16x32_bf16 v[52:55], v[116:119], v[172:175], v[52:55]
  s_add_u32 s45, s50, 35840
  buffer_load_dwordx4 v[208:211], v11, s[24:27], s45 offen offset:0
  v_mfma_f32_16x16x32_bf16 v[2:5], v[204:207], v[196:199], v[2:5]
  s_add_u32 s45, s50, 35840
  buffer_load_dwordx4 v[212:215], v11, s[24:27], s45 offen offset:1024
  v_mfma_f32_16x16x32_bf16 v[56:59], v[120:123], v[168:171], v[56:59]
  s_add_u32 s45, s50, 35840
  buffer_load_dwordx4 v[216:219], v11, s[24:27], s45 offen offset:2048
  v_mfma_f32_16x16x32_bf16 v[60:63], v[120:123], v[172:175], v[60:63]
  v_mfma_f32_16x16x32_bf16 v[64:67], v[124:127], v[168:171], v[64:67]
  v_mfma_f32_16x16x32_bf16 v[68:71], v[124:127], v[172:175], v[68:71]
  s_waitcnt lgkmcnt(0)
  s_waitcnt vmcnt(13)
  v_mfma_f32_16x16x32_bf16 v[16:19], v[72:75], v[176:179], v[16:19]
  ds_read_b64_tr_b16 v[100:101], v15 offset:19200
  ds_read_b64_tr_b16 v[102:103], v15 offset:19648
  v_mfma_f32_16x16x32_bf16 v[20:23], v[72:75], v[180:183], v[20:23]
  ds_read_b64_tr_b16 v[104:105], v15 offset:19216
  ds_read_b64_tr_b16 v[106:107], v15 offset:19664
  v_mfma_f32_16x16x32_bf16 v[24:27], v[76:79], v[176:179], v[24:27]
  ds_read_b64_tr_b16 v[108:109], v15 offset:19232
  ds_read_b64_tr_b16 v[110:111], v15 offset:19680
  v_mfma_f32_16x16x32_bf16 v[28:31], v[76:79], v[180:183], v[28:31]
  ds_read_b64_tr_b16 v[112:113], v15 offset:19248
  ds_read_b64_tr_b16 v[114:115], v15 offset:19696
  v_mfma_f32_16x16x32_bf16 v[32:35], v[80:83], v[176:179], v[32:35]
  ds_read_b64_tr_b16 v[116:117], v15 offset:19264
  ds_read_b64_tr_b16 v[118:119], v15 offset:19712
  v_mfma_f32_16x16x32_bf16 v[36:39], v[80:83], v[180:183], v[36:39]
  ds_read_b64_tr_b16 v[120:121], v15 offset:19280
  ds_read_b64_tr_b16 v[122:123], v15 offset:19728
  v_mfma_f32_16x16x32_bf16 v[40:43], v[84:87], v[176:179], v[40:43]
  ds_read_b64_tr_b16 v[124:125], v15 offset:19296
  ds_read_b64_tr_b16 v[126:127], v15 offset:19744
  v_mfma_f32_16x16x32_bf16 v[44:47], v[84:87], v[180:183], v[44:47]
  ds_read_b64_tr_b16 v[204:205], v10 offset:19200
  ds_read_b64_tr_b16 v[206:207], v10 offset:19648
  v_mfma_f32_16x16x32_bf16 v[48:51], v[88:91], v[176:179], v[48:51]
  ds_read_b128 v[196:199], v6 offset:960
  v_mfma_f32_16x16x32_bf16 v[52:55], v[88:91], v[180:183], v[52:55]
  s_add_u32 s45, s50, 40960
  buffer_load_dwordx4 v[220:223], v11, s[24:27], s45 offen offset:0
  v_mfma_f32_16x16x32_bf16 v[2:5], v[200:203], v[192:195], v[2:5]
  s_add_u32 s45, s50, 40960
  buffer_load_dwordx4 v[224:227], v11, s[24:27], s45 offen offset:1024
  v_mfma_f32_16x16x32_bf16 v[56:59], v[92:95], v[176:179], v[56:59]
  s_add_u32 s45, s50, 40960
  buffer_load_dwordx4 v[228:231], v11, s[24:27], s45 offen offset:2048
  v_mfma_f32_16x16x32_bf16 v[60:63], v[92:95], v[180:183], v[60:63]
  v_mfma_f32_16x16x32_bf16 v[64:67], v[96:99], v[176:179], v[64:67]
  v_mfma_f32_16x16x32_bf16 v[68:71], v[96:99], v[180:183], v[68:71]
  s_waitcnt lgkmcnt(0)
  s_waitcnt vmcnt(14)
  v_mfma_f32_16x16x32_bf16 v[16:19], v[100:103], v[184:187], v[16:19]
  ds_read_b64_tr_b16 v[72:73], v15 offset:23040
  ds_read_b64_tr_b16 v[74:75], v15 offset:23488
  v_mfma_f32_16x16x32_bf16 v[20:23], v[100:103], v[188:191], v[20:23]
  ds_read_b64_tr_b16 v[76:77], v15 offset:23056
  ds_read_b64_tr_b16 v[78:79], v15 offset:23504
  v_mfma_f32_16x16x32_bf16 v[24:27], v[104:107], v[184:187], v[24:27]
  ds_read_b64_tr_b16 v[80:81], v15 offset:23072
  ds_read_b64_tr_b16 v[82:83], v15 offset:23520
  v_mfma_f32_16x16x32_bf16 v[28:31], v[104:107], v[188:191], v[28:31]
  ds_read_b64_tr_b16 v[84:85], v15 offset:23088
  ds_read_b64_tr_b16 v[86:87], v15 offset:23536
  v_mfma_f32_16x16x32_bf16 v[32:35], v[108:111], v[184:187], v[32:35]
  ds_read_b64_tr_b16 v[88:89], v15 offset:23104
  ds_read_b64_tr_b16 v[90:91], v15 offset:23552
  v_mfma_f32_16x16x32_bf16 v[36:39], v[108:111], v[188:191], v[36:39]
  ds_read_b64_tr_b16 v[92:93], v15 offset:23120
  ds_read_b64_tr_b16 v[94:95], v15 offset:23568
  v_mfma_f32_16x16x32_bf16 v[40:43], v[112:115], v[184:187], v[40:43]
  ds_read_b64_tr_b16 v[96:97], v15 offset:23136
  ds_read_b64_tr_b16 v[98:99], v15 offset:23584
  v_mfma_f32_16x16x32_bf16 v[44:47], v[112:115], v[188:191], v[44:47]
  ds_read_b64_tr_b16 v[200:201], v10 offset:23040
  ds_read_b64_tr_b16 v[202:203], v10 offset:23488
  v_mfma_f32_16x16x32_bf16 v[48:51], v[116:119], v[184:187], v[48:51]
  ds_read_b128 v[192:195], v6 offset:1024
  v_mfma_f32_16x16x32_bf16 v[52:55], v[116:119], v[188:191], v[52:55]
  s_add_u32 s45, s50, 46080
  buffer_load_dwordx4 v[232:235], v11, s[24:27], s45 offen offset:0
  v_mfma_f32_16x16x32_bf16 v[2:5], v[204:207], v[196:199], v[2:5]
  s_add_u32 s45, s50, 46080
  buffer_load_dwordx4 v[236:239], v11, s[24:27], s45 offen offset:1024
  v_mfma_f32_16x16x32_bf16 v[56:59], v[120:123], v[184:187], v[56:59]
  s_add_u32 s45, s50, 46080
  buffer_load_dwordx4 v[240:243], v11, s[24:27], s45 offen offset:2048
  v_mfma_f32_16x16x32_bf16 v[60:63], v[120:123], v[188:191], v[60:63]
  v_mfma_f32_16x16x32_bf16 v[64:67], v[124:127], v[184:187], v[64:67]
  v_mfma_f32_16x16x32_bf16 v[68:71], v[124:127], v[188:191], v[68:71]
  s_waitcnt lgkmcnt(0)
  s_waitcnt vmcnt(15)
  v_mfma_f32_16x16x32_bf16 v[16:19], v[72:75], v[128:131], v[16:19]
  ds_read_b64_tr_b16 v[100:101], v15 offset:26880
  ds_read_b64_tr_b16 v[102:103], v15 offset:27328
  v_mfma_f32_16x16x32_bf16 v[20:23], v[72:75], v[132:135], v[20:23]
  ds_read_b64_tr_b16 v[104:105], v15 offset:26896
  ds_read_b64_tr_b16 v[106:107], v15 offset:27344
  v_mfma_f32_16x16x32_bf16 v[24:27], v[76:79], v[128:131], v[24:27]
  ds_read_b64_tr_b16 v[108:109], v15 offset:26912
  ds_read_b64_tr_b16 v[110:111], v15 offset:27360
  v_mfma_f32_16x16x32_bf16 v[28:31], v[76:79], v[132:135], v[28:31]
  ds_read_b64_tr_b16 v[112:113], v15 offset:26928
  ds_read_b64_tr_b16 v[114:115], v15 offset:27376
  v_mfma_f32_16x16x32_bf16 v[32:35], v[80:83], v[128:131], v[32:35]
  ds_read_b64_tr_b16 v[116:117], v15 offset:26944
  ds_read_b64_tr_b16 v[118:119], v15 offset:27392
  v_mfma_f32_16x16x32_bf16 v[36:39], v[80:83], v[132:135], v[36:39]
  ds_read_b64_tr_b16 v[120:121], v15 offset:26960
  ds_read_b64_tr_b16 v[122:123], v15 offset:27408
  v_mfma_f32_16x16x32_bf16 v[40:43], v[84:87], v[128:131], v[40:43]
  ds_read_b64_tr_b16 v[124:125], v15 offset:26976
  ds_read_b64_tr_b16 v[126:127], v15 offset:27424
  v_mfma_f32_16x16x32_bf16 v[44:47], v[84:87], v[132:135], v[44:47]
  ds_read_b64_tr_b16 v[204:205], v10 offset:26880
  ds_read_b64_tr_b16 v[206:207], v10 offset:27328
  v_mfma_f32_16x16x32_bf16 v[48:51], v[88:91], v[128:131], v[48:51]
  ds_read_b128 v[196:199], v6 offset:1088
  v_mfma_f32_16x16x32_bf16 v[52:55], v[88:91], v[132:135], v[52:55]
  v_mfma_f32_16x16x32_bf16 v[2:5], v[200:203], v[192:195], v[2:5]
  v_mfma_f32_16x16x32_bf16 v[56:59], v[92:95], v[128:131], v[56:59]
  v_mfma_f32_16x16x32_bf16 v[60:63], v[92:95], v[132:135], v[60:63]
  v_mfma_f32_16x16x32_bf16 v[64:67], v[96:99], v[128:131], v[64:67]
  v_mfma_f32_16x16x32_bf16 v[68:71], v[96:99], v[132:135], v[68:71]
  s_waitcnt lgkmcnt(0)
  s_waitcnt vmcnt(13)
  v_mfma_f32_16x16x32_bf16 v[16:19], v[100:103], v[136:139], v[16:19]
  ds_read_b64_tr_b16 v[72:73], v15 offset:30720
  ds_read_b64_tr_b16 v[74:75], v15 offset:31168
  v_mfma_f32_16x16x32_bf16 v[20:23], v[100:103], v[140:143], v[20:23]
  ds_read_b64_tr_b16 v[76:77], v15 offset:30736
  ds_read_b64_tr_b16 v[78:79], v15 offset:31184
  v_mfma_f32_16x16x32_bf16 v[24:27], v[104:107], v[136:139], v[24:27]
  ds_read_b64_tr_b16 v[80:81], v15 offset:30752
  ds_read_b64_tr_b16 v[82:83], v15 offset:31200
  v_mfma_f32_16x16x32_bf16 v[28:31], v[104:107], v[140:143], v[28:31]
  ds_read_b64_tr_b16 v[84:85], v15 offset:30768
  ds_read_b64_tr_b16 v[86:87], v15 offset:31216
  v_mfma_f32_16x16x32_bf16 v[32:35], v[108:111], v[136:139], v[32:35]
  ds_read_b64_tr_b16 v[88:89], v15 offset:30784
  ds_read_b64_tr_b16 v[90:91], v15 offset:31232
  v_mfma_f32_16x16x32_bf16 v[36:39], v[108:111], v[140:143], v[36:39]
  ds_read_b64_tr_b16 v[92:93], v15 offset:30800
  ds_read_b64_tr_b16 v[94:95], v15 offset:31248
  v_mfma_f32_16x16x32_bf16 v[40:43], v[112:115], v[136:139], v[40:43]
  ds_read_b64_tr_b16 v[96:97], v15 offset:30816
  ds_read_b64_tr_b16 v[98:99], v15 offset:31264
  v_mfma_f32_16x16x32_bf16 v[44:47], v[112:115], v[140:143], v[44:47]
  ds_read_b64_tr_b16 v[200:201], v10 offset:30720
  ds_read_b64_tr_b16 v[202:203], v10 offset:31168
  v_mfma_f32_16x16x32_bf16 v[48:51], v[116:119], v[136:139], v[48:51]
  ds_read_b128 v[192:195], v6 offset:1152
  v_mfma_f32_16x16x32_bf16 v[52:55], v[116:119], v[140:143], v[52:55]
  s_add_u32 s45, s50, 51200
  buffer_load_dwordx4 v[160:163], v11, s[24:27], s45 offen offset:0
  v_mfma_f32_16x16x32_bf16 v[2:5], v[204:207], v[196:199], v[2:5]
  s_add_u32 s45, s50, 51200
  buffer_load_dwordx4 v[164:167], v11, s[24:27], s45 offen offset:1024
  v_mfma_f32_16x16x32_bf16 v[56:59], v[120:123], v[136:139], v[56:59]
  s_add_u32 s45, s50, 51200
  buffer_load_dwordx4 v[168:171], v11, s[24:27], s45 offen offset:2048
  v_mfma_f32_16x16x32_bf16 v[60:63], v[120:123], v[140:143], v[60:63]
  v_mfma_f32_16x16x32_bf16 v[64:67], v[124:127], v[136:139], v[64:67]
  v_mfma_f32_16x16x32_bf16 v[68:71], v[124:127], v[140:143], v[68:71]
  s_waitcnt lgkmcnt(0)
  s_waitcnt vmcnt(14)
  v_mfma_f32_16x16x32_bf16 v[16:19], v[72:75], v[144:147], v[16:19]
  ds_read_b64_tr_b16 v[100:101], v15 offset:34560
  ds_read_b64_tr_b16 v[102:103], v15 offset:35008
  v_mfma_f32_16x16x32_bf16 v[20:23], v[72:75], v[148:151], v[20:23]
  ds_read_b64_tr_b16 v[104:105], v15 offset:34576
  ds_read_b64_tr_b16 v[106:107], v15 offset:35024
  v_mfma_f32_16x16x32_bf16 v[24:27], v[76:79], v[144:147], v[24:27]
  ds_read_b64_tr_b16 v[108:109], v15 offset:34592
  ds_read_b64_tr_b16 v[110:111], v15 offset:35040
  v_mfma_f32_16x16x32_bf16 v[28:31], v[76:79], v[148:151], v[28:31]
  ds_read_b64_tr_b16 v[112:113], v15 offset:34608
  ds_read_b64_tr_b16 v[114:115], v15 offset:35056
  v_mfma_f32_16x16x32_bf16 v[32:35], v[80:83], v[144:147], v[32:35]
  ds_read_b64_tr_b16 v[116:117], v15 offset:34624
  ds_read_b64_tr_b16 v[118:119], v15 offset:35072
  v_mfma_f32_16x16x32_bf16 v[36:39], v[80:83], v[148:151], v[36:39]
  ds_read_b64_tr_b16 v[120:121], v15 offset:34640
  ds_read_b64_tr_b16 v[122:123], v15 offset:35088
  v_mfma_f32_16x16x32_bf16 v[40:43], v[84:87], v[144:147], v[40:43]
  ds_read_b64_tr_b16 v[124:125], v15 offset:34656
  ds_read_b64_tr_b16 v[126:127], v15 offset:35104
  v_mfma_f32_16x16x32_bf16 v[44:47], v[84:87], v[148:151], v[44:47]
  ds_read_b64_tr_b16 v[204:205], v10 offset:34560
  ds_read_b64_tr_b16 v[206:207], v10 offset:35008
  v_mfma_f32_16x16x32_bf16 v[48:51], v[88:91], v[144:147], v[48:51]
  ds_read_b128 v[196:199], v6 offset:1216
  v_mfma_f32_16x16x32_bf16 v[52:55], v[88:91], v[148:151], v[52:55]
  s_add_u32 s45, s50, 56320
  buffer_load_dwordx4 v[172:175], v11, s[24:27], s45 offen offset:0
  v_mfma_f32_16x16x32_bf16 v[2:5], v[200:203], v[192:195], v[2:5]
  s_add_u32 s45, s50, 56320
  buffer_load_dwordx4 v[176:179], v11, s[24:27], s45 offen offset:1024
  v_mfma_f32_16x16x32_bf16 v[56:59], v[92:95], v[144:147], v[56:59]
  s_add_u32 s45, s50, 56320
  buffer_load_dwordx4 v[180:183], v11, s[24:27], s45 offen offset:2048
  v_mfma_f32_16x16x32_bf16 v[60:63], v[92:95], v[148:151], v[60:63]
  v_mfma_f32_16x16x32_bf16 v[64:67], v[96:99], v[144:147], v[64:67]
  v_mfma_f32_16x16x32_bf16 v[68:71], v[96:99], v[148:151], v[68:71]
  s_waitcnt lgkmcnt(0)
  s_waitcnt vmcnt(15)
  v_mfma_f32_16x16x32_bf16 v[16:19], v[100:103], v[152:155], v[16:19]
  s_lshl_b32 s44, s76, 11
  s_add_u32 s44, s44, 18874368
  v_lshlrev_b32 v8, 3, v1
  v_mfma_f32_16x16x32_bf16 v[20:23], v[100:103], v[156:159], v[20:23]
  buffer_load_dwordx2 v[72:73], v8, s[24:27], s44 offen offset:0
  v_mfma_f32_16x16x32_bf16 v[24:27], v[104:107], v[152:155], v[24:27]
  buffer_load_dwordx2 v[74:75], v8, s[24:27], s44 offen offset:512
  v_mfma_f32_16x16x32_bf16 v[28:31], v[104:107], v[156:159], v[28:31]
  buffer_load_dwordx2 v[76:77], v8, s[24:27], s44 offen offset:1024
  v_mfma_f32_16x16x32_bf16 v[32:35], v[108:111], v[152:155], v[32:35]
  buffer_load_dwordx2 v[78:79], v8, s[24:27], s44 offen offset:1536
  v_mfma_f32_16x16x32_bf16 v[36:39], v[108:111], v[156:159], v[36:39]
  buffer_load_dwordx2 v[80:81], v8, s[24:27], s44 offen offset:2048
  v_mfma_f32_16x16x32_bf16 v[40:43], v[112:115], v[152:155], v[40:43]
  buffer_load_dwordx2 v[82:83], v8, s[24:27], s44 offen offset:2560
  v_mfma_f32_16x16x32_bf16 v[44:47], v[112:115], v[156:159], v[44:47]
  buffer_load_dwordx2 v[84:85], v8, s[24:27], s44 offen offset:3072
  v_mfma_f32_16x16x32_bf16 v[48:51], v[116:119], v[152:155], v[48:51]
  buffer_load_dwordx2 v[86:87], v8, s[24:27], s44 offen offset:3584
  v_mfma_f32_16x16x32_bf16 v[52:55], v[116:119], v[156:159], v[52:55]
  v_mfma_f32_16x16x32_bf16 v[2:5], v[204:207], v[196:199], v[2:5]
  v_mfma_f32_16x16x32_bf16 v[56:59], v[120:123], v[152:155], v[56:59]
  v_mfma_f32_16x16x32_bf16 v[60:63], v[120:123], v[156:159], v[60:63]
  v_mfma_f32_16x16x32_bf16 v[64:67], v[124:127], v[152:155], v[64:67]
  v_mfma_f32_16x16x32_bf16 v[68:71], v[124:127], v[156:159], v[68:71]
  s_cmp_eq_u32 s43, 7
  s_nop 6
  s_cbranch_scc1 L_nosp_53
  s_lshl_b32 s44, s43, 7
  s_add_u32 s44, s44, 160000
  v_and_b32 v9, 15, v1
  v_lshlrev_b32 v9, 6, v9
  v_lshrrev_b32 v10, 4, v1
  v_lshl_add_u32 v9, v10, 4, v9
  v_add_u32 v9, s44, v9
  s_mov_b32 exec_lo, 0x00030003
  s_mov_b32 exec_hi, 0x00030003
  ds_write_b128 v9, v[2:5]
  s_mov_b64 exec, -1
L_nosp_53:
  s_waitcnt lgkmcnt(0)
  s_barrier
  s_waitcnt vmcnt(0)
  v_add_f32 v72, v72, v74
  v_add_f32 v76, v76, v78
  v_add_f32 v72, v72, v76
  v_mov_b32 v2, v72
  s_nop 1
  v_permlane16_swap_b32 v72, v2
  v_add_f32 v72, v72, v2
  v_mov_b32 v2, v72
  s_nop 1
  v_permlane32_swap_b32 v72, v2
  v_add_f32 v72, v72, v2
  v_add_f32 v73, v73, v75
  v_add_f32 v77, v77, v79
  v_add_f32 v73, v73, v77
  v_mov_b32 v2, v73
  s_nop 1
  v_permlane16_swap_b32 v73, v2
  v_add_f32 v73, v73, v2
  v_mov_b32 v2, v73
  s_nop 1
  v_permlane32_swap_b32 v73, v2
  v_add_f32 v73, v73, v2
  v_add_f32 v80, v80, v82
  v_add_f32 v84, v84, v86
  v_add_f32 v80, v80, v84
  v_mov_b32 v2, v80
  s_nop 1
  v_permlane16_swap_b32 v80, v2
  v_add_f32 v80, v80, v2
  v_mov_b32 v2, v80
  s_nop 1
  v_permlane32_swap_b32 v80, v2
  v_add_f32 v80, v80, v2
  v_add_f32 v81, v81, v83
  v_add_f32 v85, v85, v87
  v_add_f32 v81, v81, v85
  v_mov_b32 v2, v81
  s_nop 1
  v_permlane16_swap_b32 v81, v2
  v_add_f32 v81, v81, v2
  v_mov_b32 v2, v81
  s_nop 1
  v_permlane32_swap_b32 v81, v2
  v_add_f32 v81, v81, v2
  v_cmp_gt_u32 vcc, 32, v1
  s_nop 1
  v_cndmask_b32 v4, v80, v72, vcc
  v_cndmask_b32 v5, v81, v73, vcc
  v_mov_b32 v6, 0x3acccccd
  v_mul_f32 v4, v4, v6
  v_mul_f32 v5, v5, v6
  v_fma_f32 v5, -v4, v4, v5
  v_max_f32 v5, 0, v5
  v_add_f32 v5, 0x3727c5ac, v5
  v_rsq_f32 v5, v5
  v_bfe_u32 v6, v1, 4, 1
  v_lshlrev_b32 v6, 4, v6
  v_add_u32 v6, 160000, v6
  v_lshrrev_b32 v2, 5, v1
  s_mov_b32 s44, 55296
  v_mul_lo_u32 v2, v2, s44
  v_and_b32 v3, 15, v1
  v_lshl_add_u32 v2, v3, 4, v2
  v_bfe_u32 v3, v1, 4, 1
  v_lshl_add_u32 v2, v3, 3, v2
  s_lshl_b32 s44, s75, 8
  v_add_u32 v8, s44, v2
  s_mul_i32 s46, s76, 55296
  s_add_u32 s46, s46, 19922944
  s_mov_b32 s47, 0xc0135761
  s_mov_b32 s48, 0xbdd2d3e8
  v_mov_b32 v9, s47
  ds_read_b128 v[72:75], v6 offset:0
  ds_read_b128 v[76:79], v6 offset:64
  ds_read_b128 v[80:83], v6 offset:32
  ds_read_b128 v[84:87], v6 offset:96
  v_permlane32_swap_b32 v16, v20
  v_permlane32_swap_b32 v17, v21
  v_permlane32_swap_b32 v18, v22
  v_permlane32_swap_b32 v19, v23
  s_waitcnt lgkmcnt(0)
  v_fma_f32 v16, -v4, v72, v16
  v_fma_f32 v20, -v4, v80, v20
  v_fma_f32 v17, -v4, v73, v17
  v_fma_f32 v21, -v4, v81, v21
  v_fma_f32 v18, -v4, v74, v18
  v_fma_f32 v22, -v4, v82, v22
  v_fma_f32 v19, -v4, v75, v19
  v_fma_f32 v23, -v4, v83, v23
  v_fma_f32 v16, v5, v16, v76
  v_fma_f32 v20, v5, v20, v84
  v_fma_f32 v17, v5, v17, v77
  v_fma_f32 v21, v5, v21, v85
  v_fma_f32 v18, v5, v18, v78
  v_fma_f32 v22, v5, v22, v86
  v_fma_f32 v19, v5, v19, v79
  v_fma_f32 v23, v5, v23, v87
  s_add_u32 s45, s50, 0
  s_add_u32 m0, s49, 0
  s_nop 0
  buffer_load_dwordx4 v11, s[24:27], s45 offen lds
  v_mul_f32 v110, v16, v16
  v_mul_f32 v111, v17, v17
  v_mul_f32 v112, v18, v18
  v_mul_f32 v113, v19, v19
  v_fma_f32 v110, v110, s48, v9
  v_fma_f32 v111, v111, s48, v9
  v_fma_f32 v112, v112, s48, v9
  v_fma_f32 v113, v113, s48, v9
  s_add_u32 s45, s50, 1024
  s_add_u32 m0, s49, 1024
  s_nop 0
  buffer_load_dwordx4 v11, s[24:27], s45 offen lds
  v_mul_f32 v110, v110, v16
  v_mul_f32 v111, v111, v17
  v_mul_f32 v112, v112, v18
  v_mul_f32 v113, v113, v19
  v_exp_f32 v110, v110
  v_exp_f32 v111, v111
  v_exp_f32 v112, v112
  v_exp_f32 v113, v113
  v_mul_f32 v16, v16, v20
  v_mul_f32 v17, v17, v21
  v_mul_f32 v18, v18, v22
  v_mul_f32 v19, v19, v23
  s_add_u32 s45, s50, 2048
  s_add_u32 m0, s49, 2048
  s_nop 0
  buffer_load_dwordx4 v11, s[24:27], s45 offen lds
  v_add_f32 v110, 1.0, v110
  v_add_f32 v111, 1.0, v111
  v_add_f32 v112, 1.0, v112
  v_add_f32 v113, 1.0, v113
  v_rcp_f32 v110, v110
  v_rcp_f32 v111, v111
  v_rcp_f32 v112, v112
  v_rcp_f32 v113, v113
  v_mul_f32 v16, v16, v110
  v_mul_f32 v17, v17, v111
  v_mul_f32 v18, v18, v112
  v_mul_f32 v19, v19, v113
  v_cvt_pk_bf16_f32 v20, v16, v17
  v_cvt_pk_bf16_f32 v21, v18, v19
  buffer_store_dwordx2 v[20:21], v8, s[24:27], s46 offen offset:0 sc0 sc1
  ds_read_b128 v[88:91], v6 offset:128
  ds_read_b128 v[92:95], v6 offset:192
  ds_read_b128 v[96:99], v6 offset:160
  ds_read_b128 v[100:103], v6 offset:224
  v_permlane32_swap_b32 v24, v28
  v_permlane32_swap_b32 v25, v29
  v_permlane32_swap_b32 v26, v30
  v_permlane32_swap_b32 v27, v31
  s_waitcnt lgkmcnt(0)
  v_fma_f32 v24, -v4, v88, v24
  v_fma_f32 v28, -v4, v96, v28
  v_fma_f32 v25, -v4, v89, v25
  v_fma_f32 v29, -v4, v97, v29
  v_fma_f32 v26, -v4, v90, v26
  v_fma_f32 v30, -v4, v98, v30
  v_fma_f32 v27, -v4, v91, v27
  v_fma_f32 v31, -v4, v99, v31
  v_fma_f32 v24, v5, v24, v92
  v_fma_f32 v28, v5, v28, v100
  v_fma_f32 v25, v5, v25, v93
  v_fma_f32 v29, v5, v29, v101
  v_fma_f32 v26, v5, v26, v94
  v_fma_f32 v30, v5, v30, v102
  v_fma_f32 v27, v5, v27, v95
  v_fma_f32 v31, v5, v31, v103
  s_add_u32 s45, s50, 5120
  s_add_u32 m0, s49, 5120
  s_nop 0
  buffer_load_dwordx4 v11, s[24:27], s45 offen lds
  v_mul_f32 v110, v24, v24
  v_mul_f32 v111, v25, v25
  v_mul_f32 v112, v26, v26
  v_mul_f32 v113, v27, v27
  v_fma_f32 v110, v110, s48, v9
  v_fma_f32 v111, v111, s48, v9
  v_fma_f32 v112, v112, s48, v9
  v_fma_f32 v113, v113, s48, v9
  s_add_u32 s45, s50, 6144
  s_add_u32 m0, s49, 6144
  s_nop 0
  buffer_load_dwordx4 v11, s[24:27], s45 offen lds
  v_mul_f32 v110, v110, v24
  v_mul_f32 v111, v111, v25
  v_mul_f32 v112, v112, v26
  v_mul_f32 v113, v113, v27
  v_exp_f32 v110, v110
  v_exp_f32 v111, v111
  v_exp_f32 v112, v112
  v_exp_f32 v113, v113
  v_mul_f32 v24, v24, v28
  v_mul_f32 v25, v25, v29
  v_mul_f32 v26, v26, v30
  v_mul_f32 v27, v27, v31
  s_add_u32 s45, s50, 7168
  s_add_u32 m0, s49, 7168
  s_nop 0
  buffer_load_dwordx4 v11, s[24:27], s45 offen lds
  v_add_f32 v110, 1.0, v110
  v_add_f32 v111, 1.0, v111
  v_add_f32 v112, 1.0, v112
  v_add_f32 v113, 1.0, v113
  v_rcp_f32 v110, v110
  v_rcp_f32 v111, v111
  v_rcp_f32 v112, v112
  v_rcp_f32 v113, v113
  v_mul_f32 v24, v24, v110
  v_mul_f32 v25, v25, v111
  v_mul_f32 v26, v26, v112
  v_mul_f32 v27, v27, v113
  v_cvt_pk_bf16_f32 v28, v24, v25
  v_cvt_pk_bf16_f32 v29, v26, v27
  buffer_store_dwordx2 v[28:29], v8, s[24:27], s46 offen offset:256 sc0 sc1
  ds_read_b128 v[72:75], v6 offset:256
  ds_read_b128 v[76:79], v6 offset:320
  ds_read_b128 v[80:83], v6 offset:288
  ds_read_b128 v[84:87], v6 offset:352
  v_permlane32_swap_b32 v32, v36
  v_permlane32_swap_b32 v33, v37
  v_permlane32_swap_b32 v34, v38
  v_permlane32_swap_b32 v35, v39
  s_waitcnt lgkmcnt(0)
  v_fma_f32 v32, -v4, v72, v32
  v_fma_f32 v36, -v4, v80, v36
  v_fma_f32 v33, -v4, v73, v33
  v_fma_f32 v37, -v4, v81, v37
  v_fma_f32 v34, -v4, v74, v34
  v_fma_f32 v38, -v4, v82, v38
  v_fma_f32 v35, -v4, v75, v35
  v_fma_f32 v39, -v4, v83, v39
  v_fma_f32 v32, v5, v32, v76
  v_fma_f32 v36, v5, v36, v84
  v_fma_f32 v33, v5, v33, v77
  v_fma_f32 v37, v5, v37, v85
  v_fma_f32 v34, v5, v34, v78
  v_fma_f32 v38, v5, v38, v86
  v_fma_f32 v35, v5, v35, v79
  v_fma_f32 v39, v5, v39, v87
  s_add_u32 s45, s50, 10240
  s_add_u32 m0, s49, 10240
  s_nop 0
  buffer_load_dwordx4 v11, s[24:27], s45 offen lds
  v_mul_f32 v110, v32, v32
  v_mul_f32 v111, v33, v33
  v_mul_f32 v112, v34, v34
  v_mul_f32 v113, v35, v35
  v_fma_f32 v110, v110, s48, v9
  v_fma_f32 v111, v111, s48, v9
  v_fma_f32 v112, v112, s48, v9
  v_fma_f32 v113, v113, s48, v9
  s_add_u32 s45, s50, 11264
  s_add_u32 m0, s49, 11264
  s_nop 0
  buffer_load_dwordx4 v11, s[24:27], s45 offen lds
  v_mul_f32 v110, v110, v32
  v_mul_f32 v111, v111, v33
  v_mul_f32 v112, v112, v34
  v_mul_f32 v113, v113, v35
  v_exp_f32 v110, v110
  v_exp_f32 v111, v111
  v_exp_f32 v112, v112
  v_exp_f32 v113, v113
  v_mul_f32 v32, v32, v36
  v_mul_f32 v33, v33, v37
  v_mul_f32 v34, v34, v38
  v_mul_f32 v35, v35, v39
  s_add_u32 s45, s50, 12288
  s_add_u32 m0, s49, 12288
  s_nop 0
  buffer_load_dwordx4 v11, s[24:27], s45 offen lds
  v_add_f32 v110, 1.0, v110
  v_add_f32 v111, 1.0, v111
  v_add_f32 v112, 1.0, v112
  v_add_f32 v113, 1.0, v113
  v_rcp_f32 v110, v110
  v_rcp_f32 v111, v111
  v_rcp_f32 v112, v112
  v_rcp_f32 v113, v113
  v_mul_f32 v32, v32, v110
  v_mul_f32 v33, v33, v111
  v_mul_f32 v34, v34, v112
  v_mul_f32 v35, v35, v113
  v_cvt_pk_bf16_f32 v36, v32, v33
  v_cvt_pk_bf16_f32 v37, v34, v35
  buffer_store_dwordx2 v[36:37], v8, s[24:27], s46 offen offset:512 sc0 sc1
  ds_read_b128 v[88:91], v6 offset:384
  ds_read_b128 v[92:95], v6 offset:448
  ds_read_b128 v[96:99], v6 offset:416
  ds_read_b128 v[100:103], v6 offset:480
  v_permlane32_swap_b32 v40, v44
  v_permlane32_swap_b32 v41, v45
  v_permlane32_swap_b32 v42, v46
  v_permlane32_swap_b32 v43, v47
  s_waitcnt lgkmcnt(0)
  v_fma_f32 v40, -v4, v88, v40
  v_fma_f32 v44, -v4, v96, v44
  v_fma_f32 v41, -v4, v89, v41
  v_fma_f32 v45, -v4, v97, v45
  v_fma_f32 v42, -v4, v90, v42
  v_fma_f32 v46, -v4, v98, v46
  v_fma_f32 v43, -v4, v91, v43
  v_fma_f32 v47, -v4, v99, v47
  v_fma_f32 v40, v5, v40, v92
  v_fma_f32 v44, v5, v44, v100
  v_fma_f32 v41, v5, v41, v93
  v_fma_f32 v45, v5, v45, v101
  v_fma_f32 v42, v5, v42, v94
  v_fma_f32 v46, v5, v46, v102
  v_fma_f32 v43, v5, v43, v95
  v_fma_f32 v47, v5, v47, v103
  s_add_u32 s45, s50, 15360
  s_add_u32 m0, s49, 15360
  s_nop 0
  buffer_load_dwordx4 v11, s[24:27], s45 offen lds
  v_mul_f32 v110, v40, v40
  v_mul_f32 v111, v41, v41
  v_mul_f32 v112, v42, v42
  v_mul_f32 v113, v43, v43
  v_fma_f32 v110, v110, s48, v9
  v_fma_f32 v111, v111, s48, v9
  v_fma_f32 v112, v112, s48, v9
  v_fma_f32 v113, v113, s48, v9
  s_add_u32 s45, s50, 16384
  s_add_u32 m0, s49, 16384
  s_nop 0
  buffer_load_dwordx4 v11, s[24:27], s45 offen lds
  v_mul_f32 v110, v110, v40
  v_mul_f32 v111, v111, v41
  v_mul_f32 v112, v112, v42
  v_mul_f32 v113, v113, v43
  v_exp_f32 v110, v110
  v_exp_f32 v111, v111
  v_exp_f32 v112, v112
  v_exp_f32 v113, v113
  v_mul_f32 v40, v40, v44
  v_mul_f32 v41, v41, v45
  v_mul_f32 v42, v42, v46
  v_mul_f32 v43, v43, v47
  s_add_u32 s45, s50, 17408
  s_add_u32 m0, s49, 17408
  s_nop 0
  buffer_load_dwordx4 v11, s[24:27], s45 offen lds
  v_add_f32 v110, 1.0, v110
  v_add_f32 v111, 1.0, v111
  v_add_f32 v112, 1.0, v112
  v_add_f32 v113, 1.0, v113
  v_rcp_f32 v110, v110
  v_rcp_f32 v111, v111
  v_rcp_f32 v112, v112
  v_rcp_f32 v113, v113
  v_mul_f32 v40, v40, v110
  v_mul_f32 v41, v41, v111
  v_mul_f32 v42, v42, v112
  v_mul_f32 v43, v43, v113
  v_cvt_pk_bf16_f32 v44, v40, v41
  v_cvt_pk_bf16_f32 v45, v42, v43
  buffer_store_dwordx2 v[44:45], v8, s[24:27], s46 offen offset:768 sc0 sc1
  ds_read_b128 v[72:75], v6 offset:512
  ds_read_b128 v[76:79], v6 offset:576
  ds_read_b128 v[80:83], v6 offset:544
  ds_read_b128 v[84:87], v6 offset:608
  v_permlane32_swap_b32 v48, v52
  v_permlane32_swap_b32 v49, v53
  v_permlane32_swap_b32 v50, v54
  v_permlane32_swap_b32 v51, v55
  s_waitcnt lgkmcnt(0)
  v_fma_f32 v48, -v4, v72, v48
  v_fma_f32 v52, -v4, v80, v52
  v_fma_f32 v49, -v4, v73, v49
  v_fma_f32 v53, -v4, v81, v53
  v_fma_f32 v50, -v4, v74, v50
  v_fma_f32 v54, -v4, v82, v54
  v_fma_f32 v51, -v4, v75, v51
  v_fma_f32 v55, -v4, v83, v55
  v_fma_f32 v48, v5, v48, v76
  v_fma_f32 v52, v5, v52, v84
  v_fma_f32 v49, v5, v49, v77
  v_fma_f32 v53, v5, v53, v85
  v_fma_f32 v50, v5, v50, v78
  v_fma_f32 v54, v5, v54, v86
  v_fma_f32 v51, v5, v51, v79
  v_fma_f32 v55, v5, v55, v87
  s_add_u32 s45, s50, 20480
  s_add_u32 m0, s49, 20480
  s_nop 0
  buffer_load_dwordx4 v11, s[24:27], s45 offen lds
  v_mul_f32 v110, v48, v48
  v_mul_f32 v111, v49, v49
  v_mul_f32 v112, v50, v50
  v_mul_f32 v113, v51, v51
  v_fma_f32 v110, v110, s48, v9
  v_fma_f32 v111, v111, s48, v9
  v_fma_f32 v112, v112, s48, v9
  v_fma_f32 v113, v113, s48, v9
  s_add_u32 s45, s50, 21504
  s_add_u32 m0, s49, 21504
  s_nop 0
  buffer_load_dwordx4 v11, s[24:27], s45 offen lds
  v_mul_f32 v110, v110, v48
  v_mul_f32 v111, v111, v49
  v_mul_f32 v112, v112, v50
  v_mul_f32 v113, v113, v51
  v_exp_f32 v110, v110
  v_exp_f32 v111, v111
  v_exp_f32 v112, v112
  v_exp_f32 v113, v113
  v_mul_f32 v48, v48, v52
  v_mul_f32 v49, v49, v53
  v_mul_f32 v50, v50, v54
  v_mul_f32 v51, v51, v55
  s_add_u32 s45, s50, 22528
  s_add_u32 m0, s49, 22528
  s_nop 0
  buffer_load_dwordx4 v11, s[24:27], s45 offen lds
  v_add_f32 v110, 1.0, v110
  v_add_f32 v111, 1.0, v111
  v_add_f32 v112, 1.0, v112
  v_add_f32 v113, 1.0, v113
  v_rcp_f32 v110, v110
  v_rcp_f32 v111, v111
  v_rcp_f32 v112, v112
  v_rcp_f32 v113, v113
  v_mul_f32 v48, v48, v110
  v_mul_f32 v49, v49, v111
  v_mul_f32 v50, v50, v112
  v_mul_f32 v51, v51, v113
  v_cvt_pk_bf16_f32 v52, v48, v49
  v_cvt_pk_bf16_f32 v53, v50, v51
  buffer_store_dwordx2 v[52:53], v8, s[24:27], s46 offen offset:1024 sc0 sc1
  ds_read_b128 v[88:91], v6 offset:640
  ds_read_b128 v[92:95], v6 offset:704
  ds_read_b128 v[96:99], v6 offset:672
  ds_read_b128 v[100:103], v6 offset:736
  v_permlane32_swap_b32 v56, v60
  v_permlane32_swap_b32 v57, v61
  v_permlane32_swap_b32 v58, v62
  v_permlane32_swap_b32 v59, v63
  s_waitcnt lgkmcnt(0)
  v_fma_f32 v56, -v4, v88, v56
  v_fma_f32 v60, -v4, v96, v60
  v_fma_f32 v57, -v4, v89, v57
  v_fma_f32 v61, -v4, v97, v61
  v_fma_f32 v58, -v4, v90, v58
  v_fma_f32 v62, -v4, v98, v62
  v_fma_f32 v59, -v4, v91, v59
  v_fma_f32 v63, -v4, v99, v63
  v_fma_f32 v56, v5, v56, v92
  v_fma_f32 v60, v5, v60, v100
  v_fma_f32 v57, v5, v57, v93
  v_fma_f32 v61, v5, v61, v101
  v_fma_f32 v58, v5, v58, v94
  v_fma_f32 v62, v5, v62, v102
  v_fma_f32 v59, v5, v59, v95
  v_fma_f32 v63, v5, v63, v103
  s_add_u32 s45, s50, 25600
  s_add_u32 m0, s49, 25600
  s_nop 0
  buffer_load_dwordx4 v11, s[24:27], s45 offen lds
  v_mul_f32 v110, v56, v56
  v_mul_f32 v111, v57, v57
  v_mul_f32 v112, v58, v58
  v_mul_f32 v113, v59, v59
  v_fma_f32 v110, v110, s48, v9
  v_fma_f32 v111, v111, s48, v9
  v_fma_f32 v112, v112, s48, v9
  v_fma_f32 v113, v113, s48, v9
  s_add_u32 s45, s50, 26624
  s_add_u32 m0, s49, 26624
  s_nop 0
  buffer_load_dwordx4 v11, s[24:27], s45 offen lds
  v_mul_f32 v110, v110, v56
  v_mul_f32 v111, v111, v57
  v_mul_f32 v112, v112, v58
  v_mul_f32 v113, v113, v59
  v_exp_f32 v110, v110
  v_exp_f32 v111, v111
  v_exp_f32 v112, v112
  v_exp_f32 v113, v113
  v_mul_f32 v56, v56, v60
  v_mul_f32 v57, v57, v61
  v_mul_f32 v58, v58, v62
  v_mul_f32 v59, v59, v63
  s_add_u32 s45, s50, 27648
  s_add_u32 m0, s49, 27648
  s_nop 0
  buffer_load_dwordx4 v11, s[24:27], s45 offen lds
  v_add_f32 v110, 1.0, v110
  v_add_f32 v111, 1.0, v111
  v_add_f32 v112, 1.0, v112
  v_add_f32 v113, 1.0, v113
  v_rcp_f32 v110, v110
  v_rcp_f32 v111, v111
  v_rcp_f32 v112, v112
  v_rcp_f32 v113, v113
  v_mul_f32 v56, v56, v110
  v_mul_f32 v57, v57, v111
  v_mul_f32 v58, v58, v112
  v_mul_f32 v59, v59, v113
  v_cvt_pk_bf16_f32 v60, v56, v57
  v_cvt_pk_bf16_f32 v61, v58, v59
  buffer_store_dwordx2 v[60:61], v8, s[24:27], s46 offen offset:1280 sc0 sc1
  ds_read_b128 v[72:75], v6 offset:768
  ds_read_b128 v[76:79], v6 offset:832
  ds_read_b128 v[80:83], v6 offset:800
  ds_read_b128 v[84:87], v6 offset:864
  v_permlane32_swap_b32 v64, v68
  v_permlane32_swap_b32 v65, v69
  v_permlane32_swap_b32 v66, v70
  v_permlane32_swap_b32 v67, v71
  s_waitcnt lgkmcnt(0)
  v_fma_f32 v64, -v4, v72, v64
  v_fma_f32 v68, -v4, v80, v68
  v_fma_f32 v65, -v4, v73, v65
  v_fma_f32 v69, -v4, v81, v69
  v_fma_f32 v66, -v4, v74, v66
  v_fma_f32 v70, -v4, v82, v70
  v_fma_f32 v67, -v4, v75, v67
  v_fma_f32 v71, -v4, v83, v71
  v_fma_f32 v64, v5, v64, v76
  v_fma_f32 v68, v5, v68, v84
  v_fma_f32 v65, v5, v65, v77
  v_fma_f32 v69, v5, v69, v85
  v_fma_f32 v66, v5, v66, v78
  v_fma_f32 v70, v5, v70, v86
  v_fma_f32 v67, v5, v67, v79
  v_fma_f32 v71, v5, v71, v87
  s_add_u32 s45, s50, 30720
  s_add_u32 m0, s49, 30720
  s_nop 0
  buffer_load_dwordx4 v11, s[24:27], s45 offen lds
  v_mul_f32 v110, v64, v64
  v_mul_f32 v111, v65, v65
  v_mul_f32 v112, v66, v66
  v_mul_f32 v113, v67, v67
  v_fma_f32 v110, v110, s48, v9
  v_fma_f32 v111, v111, s48, v9
  v_fma_f32 v112, v112, s48, v9
  v_fma_f32 v113, v113, s48, v9
  s_add_u32 s45, s50, 31744
  s_add_u32 m0, s49, 31744
  s_nop 0
  buffer_load_dwordx4 v11, s[24:27], s45 offen lds
  v_mul_f32 v110, v110, v64
  v_mul_f32 v111, v111, v65
  v_mul_f32 v112, v112, v66
  v_mul_f32 v113, v113, v67
  v_exp_f32 v110, v110
  v_exp_f32 v111, v111
  v_exp_f32 v112, v112
  v_exp_f32 v113, v113
  v_mul_f32 v64, v64, v68
  v_mul_f32 v65, v65, v69
  v_mul_f32 v66, v66, v70
  v_mul_f32 v67, v67, v71
  s_add_u32 s45, s50, 32768
  s_add_u32 m0, s49, 32768
  s_nop 0
  buffer_load_dwordx4 v11, s[24:27], s45 offen lds
  v_add_f32 v110, 1.0, v110
  v_add_f32 v111, 1.0, v111
  v_add_f32 v112, 1.0, v112
  v_add_f32 v113, 1.0, v113
  v_rcp_f32 v110, v110
  v_rcp_f32 v111, v111
  v_rcp_f32 v112, v112
  v_rcp_f32 v113, v113
  v_mul_f32 v64, v64, v110
  v_mul_f32 v65, v65, v111
  v_mul_f32 v66, v66, v112
  v_mul_f32 v67, v67, v113
  v_cvt_pk_bf16_f32 v68, v64, v65
  v_cvt_pk_bf16_f32 v69, v66, v67
  buffer_store_dwordx2 v[68:69], v8, s[24:27], s46 offen offset:1536 sc0 sc1
  s_waitcnt vmcnt(0)
  s_barrier
  s_lshl_b32 s78, s52, 5
  s_add_u32 s78, s78, s53
  s_cmp_lg_u32 s43, 0
  s_cbranch_scc1 L_noflag_54
  s_lshl_b32 s44, s78, 6
  s_add_u32 s44, s44, 65536
  s_mov_b32 exec_lo, 1
  s_mov_b32 exec_hi, 0
  v_mov_b32 v2, s44
  v_mov_b32 v3, s42
  buffer_store_dword v3, v2, s[24:27], 0 offen sc0 sc1
  s_mov_b64 exec, -1
L_noflag_54:
  s_add_u32 s45, s50, 61440
  buffer_load_dwordx4 v[184:187], v11, s[24:27], s45 offen offset:0
  s_add_u32 s45, s50, 61440
  buffer_load_dwordx4 v[188:191], v11, s[24:27], s45 offen offset:1024
  s_add_u32 s45, s50, 61440
  buffer_load_dwordx4 v[192:195], v11, s[24:27], s45 offen offset:2048
  s_mov_b32 s45, s51
  buffer_load_dwordx4 v[196:199], v11, s[24:27], s45 offen offset:0
  s_mov_b32 s45, s51
  buffer_load_dwordx4 v[200:203], v11, s[24:27], s45 offen offset:1024
  s_mov_b32 s45, s51
  buffer_load_dwordx4 v[204:207], v11, s[24:27], s45 offen offset:2048
  s_cmp_lg_u32 s43, 0
  s_cbranch_scc1 L_nowait_55
  v_and_b32 v4, 31, v1
  s_lshl_b32 s45, s40, 5
  v_add_u32 v4, s45, v4
  v_lshlrev_b32 v4, 6, v4
  v_add_u32 v4, 65536, v4
  s_mov_b32 s44, 40000
  s_nop 0
L_poll_56:
  buffer_load_dword v8, v4, s[24:27], 0 offen sc0 sc1
  s_waitcnt vmcnt(0)
  v_cmp_ne_u32 vcc, s42, v8
  s_cmp_eq_u64 vcc, 0
  s_nop 3
  s_cbranch_scc1 L_polld_57
  s_sub_u32 s44, s44, 1
  s_cmp_lg_u32 s44, 0
  s_cbranch_scc1 L_poll_56
L_polld_57:
L_nowait_55:
  s_barrier
  s_lshl_b32 s44, s62, 1
  s_add_u32 s44, s44, s60
  s_mul_i32 s44, s44, 55296
  s_lshl_b32 s45, s77, 10
  s_add_u32 s44, s44, s45
  s_add_u32 s46, s44, 19922944
  v_lshlrev_b32 v7, 4, v1
  s_add_u32 s45, s46, 0
  buffer_load_dwordx4 v[96:99], v7, s[24:27], s45 offen offset:0
  s_add_u32 s45, s46, 53248
  buffer_load_dwordx4 v[100:103], v7, s[24:27], s45 offen offset:2048
  s_add_u32 s45, s46, 0
  buffer_load_dwordx4 v[104:107], v7, s[24:27], s45 offen offset:1024
  s_add_u32 s45, s46, 53248
  buffer_load_dwordx4 v[108:111], v7, s[24:27], s45 offen offset:3072
  s_add_u32 s45, s46, 0
  buffer_load_dwordx4 v[112:115], v7, s[24:27], s45 offen offset:2048
  s_add_u32 s45, s46, 57344
  buffer_load_dwordx4 v[116:119], v7, s[24:27], s45 offen offset:0
  s_add_u32 s45, s46, 0
  buffer_load_dwordx4 v[120:123], v7, s[24:27], s45 offen offset:3072
  s_add_u32 s45, s46, 57344
  buffer_load_dwordx4 v[124:127], v7, s[24:27], s45 offen offset:1024
  s_add_u32 s45, s46, 4096
  buffer_load_dwordx4 v[128:131], v7, s[24:27], s45 offen offset:0
  s_add_u32 s45, s46, 57344
  buffer_load_dwordx4 v[132:135], v7, s[24:27], s45 offen offset:2048
  s_add_u32 s45, s46, 4096
  buffer_load_dwordx4 v[136:139], v7, s[24:27], s45 offen offset:1024
  s_add_u32 s45, s46, 57344
  buffer_load_dwordx4 v[140:143], v7, s[24:27], s45 offen offset:3072
  s_add_u32 s45, s46, 4096
  buffer_load_dwordx4 v[144:147], v7, s[24:27], s45 offen offset:2048
  s_add_u32 s45, s46, 61440
  buffer_load_dwordx4 v[148:151], v7, s[24:27], s45 offen offset:0
  s_add_u32 s45, s46, 4096
  buffer_load_dwordx4 v[152:155], v7, s[24:27], s45 offen offset:3072
  s_add_u32 s45, s46, 61440
  buffer_load_dwordx4 v[156:159], v7, s[24:27], s45 offen offset:1024
  s_mul_i32 s44, s61, 160
  s_and_b32 s45, s43, 1
  s_mul_i32 s45, s45, 96
  s_add_u32 s44, s44, s45
  v_lshrrev_b32 v2, 4, v1
  v_lshlrev_b32 v2, 3, v2
  v_add_u32 v8, s44, v2
  s_mul_i32 s44, s63, 35840
  v_add_u32 v10, s44, v7
  v_add_u32 v14, s49, v7
  v_mov_b32 v16, 0
  v_mov_b32 v17, 0
  v_mov_b32 v18, 0
  v_mov_b32 v19, 0
  v_mov_b32 v20, 0
  v_mov_b32 v21, 0
  v_mov_b32 v22, 0
  v_mov_b32 v23, 0
  v_mov_b32 v24, 0
  v_mov_b32 v25, 0
  v_mov_b32 v26, 0
  v_mov_b32 v27, 0
  v_mov_b32 v28, 0
  v_mov_b32 v29, 0
  v_mov_b32 v30, 0
  v_mov_b32 v31, 0
  v_mov_b32 v32, 0
  v_mov_b32 v33, 0
  v_mov_b32 v34, 0
  v_mov_b32 v35, 0
  v_mov_b32 v36, 0
  v_mov_b32 v37, 0
  v_mov_b32 v38, 0
  v_mov_b32 v39, 0
  v_mov_b32 v40, 0
  v_mov_b32 v41, 0
  v_mov_b32 v42, 0
  v_mov_b32 v43, 0
  v_mov_b32 v44, 0
  v_mov_b32 v45, 0
  v_mov_b32 v46, 0
  v_mov_b32 v47, 0
  v_mov_b32 v48, 0
  v_mov_b32 v49, 0
  v_mov_b32 v50, 0
  v_mov_b32 v51, 0
  v_mov_b32 v52, 0
  v_mov_b32 v53, 0
  v_mov_b32 v54, 0
  v_mov_b32 v55, 0
  ds_read_b128 v[56:59], v10 offset:0
  ds_read_b128 v[60:63], v10 offset:1024
  ds_read_b128 v[64:67], v10 offset:2048
  ds_read_b128 v[68:71], v10 offset:3072
  ds_read_b128 v[72:75], v10 offset:4096
  s_waitcnt lgkmcnt(0)
  s_barrier
  s_waitcnt vmcnt(14)
  v_mfma_f32_16x16x32_bf16 v[16:19], v[56:59], v[96:99], v[16:19]
  ds_read_b128 v[76:79], v10 offset:5120
  v_mfma_f32_16x16x32_bf16 v[36:39], v[56:59], v[100:103], v[36:39]
  ds_read_b128 v[80:83], v10 offset:6144
  v_mfma_f32_16x16x32_bf16 v[20:23], v[60:63], v[96:99], v[20:23]
  ds_read_b128 v[84:87], v10 offset:7168
  v_mfma_f32_16x16x32_bf16 v[40:43], v[60:63], v[100:103], v[40:43]
  ds_read_b128 v[88:91], v10 offset:8192
  v_mfma_f32_16x16x32_bf16 v[24:27], v[64:67], v[96:99], v[24:27]
  ds_read_b128 v[92:95], v10 offset:9216
  v_mfma_f32_16x16x32_bf16 v[44:47], v[64:67], v[100:103], v[44:47]
  ds_write_b128 v14, v[208:211] offset:0
  v_mfma_f32_16x16x32_bf16 v[28:31], v[68:71], v[96:99], v[28:31]
  ds_write_b128 v14, v[212:215] offset:1024
  v_mfma_f32_16x16x32_bf16 v[48:51], v[68:71], v[100:103], v[48:51]
  ds_write_b128 v14, v[216:219] offset:2048
  v_mfma_f32_16x16x32_bf16 v[32:35], v[72:75], v[96:99], v[32:35]
  v_mfma_f32_16x16x32_bf16 v[52:55], v[72:75], v[100:103], v[52:55]
  s_waitcnt lgkmcnt(0)
  s_barrier
  s_waitcnt vmcnt(12)
  v_mfma_f32_16x16x32_bf16 v[16:19], v[76:79], v[104:107], v[16:19]
  ds_read_b128 v[56:59], v10 offset:10240
  v_mfma_f32_16x16x32_bf16 v[36:39], v[76:79], v[108:111], v[36:39]
  ds_read_b128 v[60:63], v10 offset:11264
  v_mfma_f32_16x16x32_bf16 v[20:23], v[80:83], v[104:107], v[20:23]
  ds_read_b128 v[64:67], v10 offset:12288
  v_mfma_f32_16x16x32_bf16 v[40:43], v[80:83], v[108:111], v[40:43]
  ds_read_b128 v[68:71], v10 offset:13312
  v_mfma_f32_16x16x32_bf16 v[24:27], v[84:87], v[104:107], v[24:27]
  ds_read_b128 v[72:75], v10 offset:14336
  v_mfma_f32_16x16x32_bf16 v[44:47], v[84:87], v[108:111], v[44:47]
  ds_write_b128 v14, v[220:223] offset:5120
  v_mfma_f32_16x16x32_bf16 v[28:31], v[88:91], v[104:107], v[28:31]
  ds_write_b128 v14, v[224:227] offset:6144
  v_mfma_f32_16x16x32_bf16 v[48:51], v[88:91], v[108:111], v[48:51]
  ds_write_b128 v14, v[228:231] offset:7168
  v_mfma_f32_16x16x32_bf16 v[32:35], v[92:95], v[104:107], v[32:35]
  s_add_u32 s45, s46, 8192
  buffer_load_dwordx4 v[96:99], v7, s[24:27], s45 offen offset:0
  v_mfma_f32_16x16x32_bf16 v[52:55], v[92:95], v[108:111], v[52:55]
  s_add_u32 s45, s46, 61440
  buffer_load_dwordx4 v[100:103], v7, s[24:27], s45 offen offset:2048
  s_waitcnt lgkmcnt(0)
  s_barrier
  s_waitcnt vmcnt(12)
  v_mfma_f32_16x16x32_bf16 v[16:19], v[56:59], v[112:115], v[16:19]
  ds_read_b128 v[76:79], v10 offset:15360
  v_mfma_f32_16x16x32_bf16 v[36:39], v[56:59], v[116:119], v[36:39]
  ds_read_b128 v[80:83], v10 offset:16384
  v_mfma_f32_16x16x32_bf16 v[20:23], v[60:63], v[112:115], v[20:23]
  ds_read_b128 v[84:87], v10 offset:17408
  v_mfma_f32_16x16x32_bf16 v[40:43], v[60:63], v[116:119], v[40:43]
  ds_read_b128 v[88:91], v10 offset:18432
  v_mfma_f32_16x16x32_bf16 v[24:27], v[64:67], v[112:115], v[24:27]
  ds_read_b128 v[92:95], v10 offset:19456
  v_mfma_f32_16x16x32_bf16 v[44:47], v[64:67], v[116:119], v[44:47]
  ds_write_b128 v14, v[232:235] offset:10240
  v_mfma_f32_16x16x32_bf16 v[28:31], v[68:71], v[112:115], v[28:31]
  ds_write_b128 v14, v[236:239] offset:11264
  v_mfma_f32_16x16x32_bf16 v[48:51], v[68:71], v[116:119], v[48:51]
  ds_write_b128 v14, v[240:243] offset:12288
  v_mfma_f32_16x16x32_bf16 v[32:35], v[72:75], v[112:115], v[32:35]
  s_add_u32 s45, s46, 8192
  buffer_load_dwordx4 v[104:107], v7, s[24:27], s45 offen offset:1024
  v_mfma_f32_16x16x32_bf16 v[52:55], v[72:75], v[116:119], v[52:55]
  s_add_u32 s45, s46, 61440
  buffer_load_dwordx4 v[108:111], v7, s[24:27], s45 offen offset:3072
  s_waitcnt lgkmcnt(0)
  s_barrier
  s_waitcnt vmcnt(12)
  v_mfma_f32_16x16x32_bf16 v[16:19], v[76:79], v[120:123], v[16:19]
  ds_read_b128 v[56:59], v10 offset:20480
  v_mfma_f32_16x16x32_bf16 v[36:39], v[76:79], v[124:127], v[36:39]
  ds_read_b128 v[60:63], v10 offset:21504
  v_mfma_f32_16x16x32_bf16 v[20:23], v[80:83], v[120:123], v[20:23]
  ds_read_b128 v[64:67], v10 offset:22528
  v_mfma_f32_16x16x32_bf16 v[40:43], v[80:83], v[124:127], v[40:43]
  ds_read_b128 v[68:71], v10 offset:23552
  v_mfma_f32_16x16x32_bf16 v[24:27], v[84:87], v[120:123], v[24:27]
  ds_read_b128 v[72:75], v10 offset:24576
  v_mfma_f32_16x16x32_bf16 v[44:47], v[84:87], v[124:127], v[44:47]
  ds_write_b128 v14, v[160:163] offset:15360
  v_mfma_f32_16x16x32_bf16 v[28:31], v[88:91], v[120:123], v[28:31]
  ds_write_b128 v14, v[164:167] offset:16384
  v_mfma_f32_16x16x32_bf16 v[48:51], v[88:91], v[124:127], v[48:51]
  ds_write_b128 v14, v[168:171] offset:17408
  v_mfma_f32_16x16x32_bf16 v[32:35], v[92:95], v[120:123], v[32:35]
  s_add_u32 s45, s46, 8192
  buffer_load_dwordx4 v[112:115], v7, s[24:27], s45 offen offset:2048
  v_mfma_f32_16x16x32_bf16 v[52:55], v[92:95], v[124:127], v[52:55]
  s_add_u32 s45, s46, 65536
  buffer_load_dwordx4 v[116:119], v7, s[24:27], s45 offen offset:0
  s_waitcnt lgkmcnt(0)
  s_barrier
  s_waitcnt vmcnt(12)
  v_mfma_f32_16x16x32_bf16 v[16:19], v[56:59], v[128:131], v[16:19]
  ds_read_b128 v[76:79], v10 offset:25600
  v_mfma_f32_16x16x32_bf16 v[36:39], v[56:59], v[132:135], v[36:39]
  ds_read_b128 v[80:83], v10 offset:26624
  v_mfma_f32_16x16x32_bf16 v[20:23], v[60:63], v[128:131], v[20:23]
  ds_read_b128 v[84:87], v10 offset:27648
  v_mfma_f32_16x16x32_bf16 v[40:43], v[60:63], v[132:135], v[40:43]
  ds_read_b128 v[88:91], v10 offset:28672
  v_mfma_f32_16x16x32_bf16 v[24:27], v[64:67], v[128:131], v[24:27]
  ds_read_b128 v[92:95], v10 offset:29696
  v_mfma_f32_16x16x32_bf16 v[44:47], v[64:67], v[132:135], v[44:47]
  ds_write_b128 v14, v[172:175] offset:20480
  v_mfma_f32_16x16x32_bf16 v[28:31], v[68:71], v[128:131], v[28:31]
  ds_write_b128 v14, v[176:179] offset:21504
  v_mfma_f32_16x16x32_bf16 v[48:51], v[68:71], v[132:135], v[48:51]
  ds_write_b128 v14, v[180:183] offset:22528
  v_mfma_f32_16x16x32_bf16 v[32:35], v[72:75], v[128:131], v[32:35]
  s_add_u32 s45, s46, 8192
  buffer_load_dwordx4 v[120:123], v7, s[24:27], s45 offen offset:3072
  v_mfma_f32_16x16x32_bf16 v[52:55], v[72:75], v[132:135], v[52:55]
  s_add_u32 s45, s46, 65536
  buffer_load_dwordx4 v[124:127], v7, s[24:27], s45 offen offset:1024
  s_waitcnt lgkmcnt(0)
  s_barrier
  s_waitcnt vmcnt(12)
  v_mfma_f32_16x16x32_bf16 v[16:19], v[76:79], v[136:139], v[16:19]
  ds_read_b128 v[56:59], v10 offset:30720
  v_mfma_f32_16x16x32_bf16 v[36:39], v[76:79], v[140:143], v[36:39]
  ds_read_b128 v[60:63], v10 offset:31744
  v_mfma_f32_16x16x32_bf16 v[20:23], v[80:83], v[136:139], v[20:23]
  ds_read_b128 v[64:67], v10 offset:32768
  v_mfma_f32_16x16x32_bf16 v[40:43], v[80:83], v[140:143], v[40:43]
  ds_read_b128 v[68:71], v10 offset:33792
  v_mfma_f32_16x16x32_bf16 v[24:27], v[84:87], v[136:139], v[24:27]
  ds_read_b128 v[72:75], v10 offset:34816
  v_mfma_f32_16x16x32_bf16 v[44:47], v[84:87], v[140:143], v[44:47]
  s_waitcnt vmcnt(27)
  ds_write_b128 v14, v[184:187] offset:25600
  v_mfma_f32_16x16x32_bf16 v[28:31], v[88:91], v[136:139], v[28:31]
  ds_write_b128 v14, v[188:191] offset:26624
  v_mfma_f32_16x16x32_bf16 v[48:51], v[88:91], v[140:143], v[48:51]
  ds_write_b128 v14, v[192:195] offset:27648
  v_mfma_f32_16x16x32_bf16 v[32:35], v[92:95], v[136:139], v[32:35]
  s_add_u32 s45, s46, 12288
  buffer_load_dwordx4 v[128:131], v7, s[24:27], s45 offen offset:0
  v_mfma_f32_16x16x32_bf16 v[52:55], v[92:95], v[140:143], v[52:55]
  s_add_u32 s45, s46, 65536
  buffer_load_dwordx4 v[132:135], v7, s[24:27], s45 offen offset:2048
  s_waitcnt lgkmcnt(0)
  s_barrier
  s_waitcnt vmcnt(12)
  v_mfma_f32_16x16x32_bf16 v[16:19], v[56:59], v[144:147], v[16:19]
  ds_read_b128 v[76:79], v10 offset:0
  v_mfma_f32_16x16x32_bf16 v[36:39], v[56:59], v[148:151], v[36:39]
  ds_read_b128 v[80:83], v10 offset:1024
  v_mfma_f32_16x16x32_bf16 v[20:23], v[60:63], v[144:147], v[20:23]
  ds_read_b128 v[84:87], v10 offset:2048
  v_mfma_f32_16x16x32_bf16 v[40:43], v[60:63], v[148:151], v[40:43]
  ds_read_b128 v[88:91], v10 offset:3072
  v_mfma_f32_16x16x32_bf16 v[24:27], v[64:67], v[144:147], v[24:27]
  ds_read_b128 v[92:95], v10 offset:4096
  v_mfma_f32_16x16x32_bf16 v[44:47], v[64:67], v[148:151], v[44:47]
  s_waitcnt vmcnt(26)
  ds_write_b128 v14, v[196:199] offset:30720
  v_mfma_f32_16x16x32_bf16 v[28:31], v[68:71], v[144:147], v[28:31]
  ds_write_b128 v14, v[200:203] offset:31744
  v_mfma_f32_16x16x32_bf16 v[48:51], v[68:71], v[148:151], v[48:51]
  ds_write_b128 v14, v[204:207] offset:32768
  v_mfma_f32_16x16x32_bf16 v[32:35], v[72:75], v[144:147], v[32:35]
  s_add_u32 s45, s46, 12288
  buffer_load_dwordx4 v[136:139], v7, s[24:27], s45 offen offset:1024
  v_mfma_f32_16x16x32_bf16 v[52:55], v[72:75], v[148:151], v[52:55]
  s_add_u32 s45, s46, 65536
  buffer_load_dwordx4 v[140:143], v7, s[24:27], s45 offen offset:3072
  s_waitcnt lgkmcnt(0)
  s_barrier
  s_waitcnt vmcnt(12)
  v_mfma_f32_16x16x32_bf16 v[16:19], v[76:79], v[152:155], v[16:19]
  ds_read_b128 v[56:59], v10 offset:5120
  v_mfma_f32_16x16x32_bf16 v[36:39], v[76:79], v[156:159], v[36:39]
  ds_read_b128 v[60:63], v10 offset:6144
  v_mfma_f32_16x16x32_bf16 v[20:23], v[80:83], v[152:155], v[20:23]
  ds_read_b128 v[64:67], v10 offset:7168
  v_mfma_f32_16x16x32_bf16 v[40:43], v[80:83], v[156:159], v[40:43]
  ds_read_b128 v[68:71], v10 offset:8192
  v_mfma_f32_16x16x32_bf16 v[24:27], v[84:87], v[152:155], v[24:27]
  ds_read_b128 v[72:75], v10 offset:9216
  v_mfma_f32_16x16x32_bf16 v[44:47], v[84:87], v[156:159], v[44:47]
  v_mfma_f32_16x16x32_bf16 v[28:31], v[88:91], v[152:155], v[28:31]
  v_mfma_f32_16x16x32_bf16 v[48:51], v[88:91], v[156:159], v[48:51]
  v_mfma_f32_16x16x32_bf16 v[32:35], v[92:95], v[152:155], v[32:35]
  v_mfma_f32_16x16x32_bf16 v[52:55], v[92:95], v[156:159], v[52:55]
  s_waitcnt lgkmcnt(0)
  s_waitcnt vmcnt(10)
  v_mfma_f32_16x16x32_bf16 v[16:19], v[56:59], v[96:99], v[16:19]
  ds_read_b128 v[76:79], v10 offset:10240
  v_mfma_f32_16x16x32_bf16 v[36:39], v[56:59], v[100:103], v[36:39]
  ds_read_b128 v[80:83], v10 offset:11264
  v_mfma_f32_16x16x32_bf16 v[20:23], v[60:63], v[96:99], v[20:23]
  ds_read_b128 v[84:87], v10 offset:12288
  v_mfma_f32_16x16x32_bf16 v[40:43], v[60:63], v[100:103], v[40:43]
  ds_read_b128 v[88:91], v10 offset:13312
  v_mfma_f32_16x16x32_bf16 v[24:27], v[64:67], v[96:99], v[24:27]
  ds_read_b128 v[92:95], v10 offset:14336
  v_mfma_f32_16x16x32_bf16 v[44:47], v[64:67], v[100:103], v[44:47]
  s_lshl_b32 s73, s40, 13
  s_add_u32 s73, s73, 203008
  v_mfma_f32_16x16x32_bf16 v[28:31], v[68:71], v[96:99], v[28:31]
  buffer_load_dwordx2 v[160:161], v8, s[24:27], s73 offen offset:0
  v_mfma_f32_16x16x32_bf16 v[48:51], v[68:71], v[100:103], v[48:51]
  buffer_load_dwordx2 v[162:163], v8, s[24:27], s73 offen offset:32
  v_mfma_f32_16x16x32_bf16 v[32:35], v[72:75], v[96:99], v[32:35]
  buffer_load_dwordx2 v[164:165], v8, s[24:27], s73 offen offset:64
  v_mfma_f32_16x16x32_bf16 v[52:55], v[72:75], v[100:103], v[52:55]
  s_waitcnt lgkmcnt(0)
  s_waitcnt vmcnt(11)
  v_mfma_f32_16x16x32_bf16 v[16:19], v[76:79], v[104:107], v[16:19]
  ds_read_b128 v[56:59], v10 offset:15360
  v_mfma_f32_16x16x32_bf16 v[36:39], v[76:79], v[108:111], v[36:39]
  ds_read_b128 v[60:63], v10 offset:16384
  v_mfma_f32_16x16x32_bf16 v[20:23], v[80:83], v[104:107], v[20:23]
  ds_read_b128 v[64:67], v10 offset:17408
  v_mfma_f32_16x16x32_bf16 v[40:43], v[80:83], v[108:111], v[40:43]
  ds_read_b128 v[68:71], v10 offset:18432
  v_mfma_f32_16x16x32_bf16 v[24:27], v[84:87], v[104:107], v[24:27]
  ds_read_b128 v[72:75], v10 offset:19456
  v_mfma_f32_16x16x32_bf16 v[44:47], v[84:87], v[108:111], v[44:47]
  v_mfma_f32_16x16x32_bf16 v[28:31], v[88:91], v[104:107], v[28:31]
  v_mfma_f32_16x16x32_bf16 v[48:51], v[88:91], v[108:111], v[48:51]
  v_mfma_f32_16x16x32_bf16 v[32:35], v[92:95], v[104:107], v[32:35]
  v_mfma_f32_16x16x32_bf16 v[52:55], v[92:95], v[108:111], v[52:55]
  s_waitcnt lgkmcnt(0)
  s_waitcnt vmcnt(9)
  v_mfma_f32_16x16x32_bf16 v[16:19], v[56:59], v[112:115], v[16:19]
  ds_read_b128 v[76:79], v10 offset:20480
  v_mfma_f32_16x16x32_bf16 v[36:39], v[56:59], v[116:119], v[36:39]
  ds_read_b128 v[80:83], v10 offset:21504
  v_mfma_f32_16x16x32_bf16 v[20:23], v[60:63], v[112:115], v[20:23]
  ds_read_b128 v[84:87], v10 offset:22528
  v_mfma_f32_16x16x32_bf16 v[40:43], v[60:63], v[116:119], v[40:43]
  ds_read_b128 v[88:91], v10 offset:23552
  v_mfma_f32_16x16x32_bf16 v[24:27], v[64:67], v[112:115], v[24:27]
  ds_read_b128 v[92:95], v10 offset:24576
  v_mfma_f32_16x16x32_bf16 v[44:47], v[64:67], v[116:119], v[44:47]
  v_mfma_f32_16x16x32_bf16 v[28:31], v[68:71], v[112:115], v[28:31]
  v_mfma_f32_16x16x32_bf16 v[48:51], v[68:71], v[116:119], v[48:51]
  v_mfma_f32_16x16x32_bf16 v[32:35], v[72:75], v[112:115], v[32:35]
  v_mfma_f32_16x16x32_bf16 v[52:55], v[72:75], v[116:119], v[52:55]
  s_waitcnt lgkmcnt(0)
  s_waitcnt vmcnt(7)
  v_mfma_f32_16x16x32_bf16 v[16:19], v[76:79], v[120:123], v[16:19]
  ds_read_b128 v[56:59], v10 offset:25600
  v_mfma_f32_16x16x32_bf16 v[36:39], v[76:79], v[124:127], v[36:39]
  ds_read_b128 v[60:63], v10 offset:26624
  v_mfma_f32_16x16x32_bf16 v[20:23], v[80:83], v[120:123], v[20:23]
  ds_read_b128 v[64:67], v10 offset:27648
  v_mfma_f32_16x16x32_bf16 v[40:43], v[80:83], v[124:127], v[40:43]
  ds_read_b128 v[68:71], v10 offset:28672
  v_mfma_f32_16x16x32_bf16 v[24:27], v[84:87], v[120:123], v[24:27]
  ds_read_b128 v[72:75], v10 offset:29696
  v_mfma_f32_16x16x32_bf16 v[44:47], v[84:87], v[124:127], v[44:47]
  v_mfma_f32_16x16x32_bf16 v[28:31], v[88:91], v[120:123], v[28:31]
  v_mfma_f32_16x16x32_bf16 v[48:51], v[88:91], v[124:127], v[48:51]
  v_mfma_f32_16x16x32_bf16 v[32:35], v[92:95], v[120:123], v[32:35]
  v_mfma_f32_16x16x32_bf16 v[52:55], v[92:95], v[124:127], v[52:55]
  s_waitcnt lgkmcnt(0)
  s_waitcnt vmcnt(5)
  v_mfma_f32_16x16x32_bf16 v[16:19], v[56:59], v[128:131], v[16:19]
  ds_read_b128 v[76:79], v10 offset:30720
  v_mfma_f32_16x16x32_bf16 v[36:39], v[56:59], v[132:135], v[36:39]
  ds_read_b128 v[80:83], v10 offset:31744
  v_mfma_f32_16x16x32_bf16 v[20:23], v[60:63], v[128:131], v[20:23]
  ds_read_b128 v[84:87], v10 offset:32768
  v_mfma_f32_16x16x32_bf16 v[40:43], v[60:63], v[132:135], v[40:43]
  ds_read_b128 v[88:91], v10 offset:33792
  v_mfma_f32_16x16x32_bf16 v[24:27], v[64:67], v[128:131], v[24:27]
  ds_read_b128 v[92:95], v10 offset:34816
  v_mfma_f32_16x16x32_bf16 v[44:47], v[64:67], v[132:135], v[44:47]
  v_mfma_f32_16x16x32_bf16 v[28:31], v[68:71], v[128:131], v[28:31]
  v_mfma_f32_16x16x32_bf16 v[48:51], v[68:71], v[132:135], v[48:51]
  v_mfma_f32_16x16x32_bf16 v[32:35], v[72:75], v[128:131], v[32:35]
  v_mfma_f32_16x16x32_bf16 v[52:55], v[72:75], v[132:135], v[52:55]
  s_cmp_ge_u32 s63, 2
  s_nop 6
  s_cbranch_scc1 L_p5s_59
  s_waitcnt lgkmcnt(0)
  s_waitcnt vmcnt(3)
  v_mfma_f32_16x16x32_bf16 v[16:19], v[76:79], v[136:139], v[16:19]
  v_mfma_f32_16x16x32_bf16 v[36:39], v[76:79], v[140:143], v[36:39]
  v_mfma_f32_16x16x32_bf16 v[20:23], v[80:83], v[136:139], v[20:23]
  v_mfma_f32_16x16x32_bf16 v[40:43], v[80:83], v[140:143], v[40:43]
  v_mfma_f32_16x16x32_bf16 v[24:27], v[84:87], v[136:139], v[24:27]
  v_mfma_f32_16x16x32_bf16 v[44:47], v[84:87], v[140:143], v[44:47]
  v_mfma_f32_16x16x32_bf16 v[28:31], v[88:91], v[136:139], v[28:31]
  v_mfma_f32_16x16x32_bf16 v[48:51], v[88:91], v[140:143], v[48:51]
  v_mfma_f32_16x16x32_bf16 v[32:35], v[92:95], v[136:139], v[32:35]
  v_mfma_f32_16x16x32_bf16 v[52:55], v[92:95], v[140:143], v[52:55]
  s_nop 7
L_p5s_59:
  s_waitcnt vmcnt(0) lgkmcnt(0)
  s_barrier
  s_mul_i32 s44, s43, 10240
  v_lshlrev_b32 v2, 4, v1
  v_add_u32 v3, s44, v2
  ds_write_b128 v3, v[16:19] offset:0
  ds_write_b128 v3, v[20:23] offset:1024
  ds_write_b128 v3, v[24:27] offset:2048
  ds_write_b128 v3, v[28:31] offset:3072
  ds_write_b128 v3, v[32:35] offset:4096
  ds_write_b128 v3, v[36:39] offset:5120
  ds_write_b128 v3, v[40:43] offset:6144
  ds_write_b128 v3, v[44:47] offset:7168
  ds_write_b128 v3, v[48:51] offset:8192
  ds_write_b128 v3, v[52:55] offset:9216
  s_lshr_b32 s44, s43, 2
  s_mul_i32 s44, s44, 10240
  s_bfe_u32 s45, s43, 0x10001
  s_mul_i32 s45, s45, 5120
  s_add_u32 s44, s44, s45
  s_and_b32 s45, s43, 1
  s_mul_i32 s45, s45, 3072
  s_add_u32 s44, s44, s45
  v_add_u32 v3, s44, v2
  s_waitcnt lgkmcnt(0)
  s_barrier
  ds_read_b128 v[56:59], v3 offset:0
  ds_read_b128 v[60:63], v3 offset:1024
  ds_read_b128 v[64:67], v3 offset:2048
  ds_read_b128 v[68:71], v3 offset:20480
  ds_read_b128 v[72:75], v3 offset:21504
  ds_read_b128 v[76:79], v3 offset:22528
  ds_read_b128 v[80:83], v3 offset:40960
  ds_read_b128 v[84:87], v3 offset:41984
  ds_read_b128 v[88:91], v3 offset:43008
  ds_read_b128 v[92:95], v3 offset:61440
  ds_read_b128 v[96:99], v3 offset:62464
  ds_read_b128 v[100:103], v3 offset:63488
  s_waitcnt lgkmcnt(0)
  v_add_f32 v16, v56, v68
  v_add_f32 v32, v80, v92
  v_add_f32 v16, v16, v32
  v_add_f32 v17, v57, v69
  v_add_f32 v33, v81, v93
  v_add_f32 v17, v17, v33
  v_add_f32 v18, v58, v70
  v_add_f32 v34, v82, v94
  v_add_f32 v18, v18, v34
  v_add_f32 v19, v59, v71
  v_add_f32 v35, v83, v95
  v_add_f32 v19, v19, v35
  v_add_f32 v20, v60, v72
  v_add_f32 v36, v84, v96
  v_add_f32 v20, v20, v36
  v_add_f32 v21, v61, v73
  v_add_f32 v37, v85, v97
  v_add_f32 v21, v21, v37
  v_add_f32 v22, v62, v74
  v_add_f32 v38, v86, v98
  v_add_f32 v22, v22, v38
  v_add_f32 v23, v63, v75
  v_add_f32 v39, v87, v99
  v_add_f32 v23, v23, v39
  v_add_f32 v24, v64, v76
  v_add_f32 v40, v88, v100
  v_add_f32 v24, v24, v40
  v_add_f32 v25, v65, v77
  v_add_f32 v41, v89, v101
  v_add_f32 v25, v25, v41
  v_add_f32 v26, v66, v78
  v_add_f32 v42, v90, v102
  v_add_f32 v26, v26, v42
  v_add_f32 v27, v67, v79
  v_add_f32 v43, v91, v103
  v_add_f32 v27, v27, v43
  v_and_b32 v2, 15, v1
  s_lshl_b32 s44, s72, 4
  v_add_u32 v2, s44, v2
  s_movk_i32 s44, 1280
  v_mul_lo_u32 v2, v2, s44
  v_add_u32 v9, v2, v8
  s_mov_b32 s32, s22
  s_mov_b32 s33, s23
  s_mov_b32 s34, 2621440
  s_mov_b32 s35, 0x20000
  v_cvt_pk_bf16_f32 v2, v16, v17
  v_lshlrev_b32 v16, 16, v2
  v_and_b32 v17, 0xffff0000, v2
  v_cvt_pk_bf16_f32 v2, v18, v19
  v_lshlrev_b32 v18, 16, v2
  v_and_b32 v19, 0xffff0000, v2
  v_lshlrev_b32 v32, 16, v160
  v_and_b32 v33, 0xffff0000, v160
  v_lshlrev_b32 v34, 16, v161
  v_and_b32 v35, 0xffff0000, v161
  v_mul_f32 v16, v16, v32
  v_mul_f32 v17, v17, v33
  v_mul_f32 v18, v18, v34
  v_mul_f32 v19, v19, v35
  v_cvt_pk_bf16_f32 v2, v16, v17
  v_lshlrev_b32 v16, 16, v2
  v_and_b32 v17, 0xffff0000, v2
  v_cvt_pk_bf16_f32 v2, v18, v19
  v_lshlrev_b32 v18, 16, v2
  v_and_b32 v19, 0xffff0000, v2
  v_add_f32 v16, v16, v244
  v_add_f32 v17, v17, v245
  v_add_f32 v18, v18, v246
  v_add_f32 v19, v19, v247
  v_cvt_pk_bf16_f32 v36, v16, v17
  v_cvt_pk_bf16_f32 v37, v18, v19
  buffer_store_dwordx2 v[36:37], v9, s[32:35], 0 offen offset:0
  v_cvt_pk_bf16_f32 v2, v20, v21
  v_lshlrev_b32 v20, 16, v2
  v_and_b32 v21, 0xffff0000, v2
  v_cvt_pk_bf16_f32 v2, v22, v23
  v_lshlrev_b32 v22, 16, v2
  v_and_b32 v23, 0xffff0000, v2
  v_lshlrev_b32 v32, 16, v162
  v_and_b32 v33, 0xffff0000, v162
  v_lshlrev_b32 v34, 16, v163
  v_and_b32 v35, 0xffff0000, v163
  v_mul_f32 v20, v20, v32
  v_mul_f32 v21, v21, v33
  v_mul_f32 v22, v22, v34
  v_mul_f32 v23, v23, v35
  v_cvt_pk_bf16_f32 v2, v20, v21
  v_lshlrev_b32 v20, 16, v2
  v_and_b32 v21, 0xffff0000, v2
  v_cvt_pk_bf16_f32 v2, v22, v23
  v_lshlrev_b32 v22, 16, v2
  v_and_b32 v23, 0xffff0000, v2
  v_add_f32 v20, v20, v248
  v_add_f32 v21, v21, v249
  v_add_f32 v22, v22, v250
  v_add_f32 v23, v23, v251
  v_cvt_pk_bf16_f32 v38, v20, v21
  v_cvt_pk_bf16_f32 v39, v22, v23
  buffer_store_dwordx2 v[38:39], v9, s[32:35], 0 offen offset:32
  s_bitcmp1_b32 s43, 0
  s_cbranch_scc1 L_p5e_60
  v_cvt_pk_bf16_f32 v2, v24, v25
  v_lshlrev_b32 v24, 16, v2
  v_and_b32 v25, 0xffff0000, v2
  v_cvt_pk_bf16_f32 v2, v26, v27
  v_lshlrev_b32 v26, 16, v2
  v_and_b32 v27, 0xffff0000, v2
  v_lshlrev_b32 v32, 16, v164
  v_and_b32 v33, 0xffff0000, v164
  v_lshlrev_b32 v34, 16, v165
  v_and_b32 v35, 0xffff0000, v165
  v_mul_f32 v24, v24, v32
  v_mul_f32 v25, v25, v33
  v_mul_f32 v26, v26, v34
  v_mul_f32 v27, v27, v35
  v_cvt_pk_bf16_f32 v2, v24, v25
  v_lshlrev_b32 v24, 16, v2
  v_and_b32 v25, 0xffff0000, v2
  v_cvt_pk_bf16_f32 v2, v26, v27
  v_lshlrev_b32 v26, 16, v2
  v_and_b32 v27, 0xffff0000, v2
  v_add_f32 v24, v24, v252
  v_add_f32 v25, v25, v253
  v_add_f32 v26, v26, v254
  v_add_f32 v27, v27, v255
  v_cvt_pk_bf16_f32 v40, v24, v25
  v_cvt_pk_bf16_f32 v41, v26, v27
  buffer_store_dwordx2 v[40:41], v9, s[32:35], 0 offen offset:64
  s_nop 0
L_p5e_60:
  s_cmp_lg_u32 s2, 0
  s_cbranch_scc1 L_noep_61
  s_cmp_lg_u32 s43, 0
  s_cbranch_scc1 L_noep_61
  s_mov_b32 exec_lo, 1
  s_mov_b32 exec_hi, 0
  v_mov_b32 v2, 131072
  v_mov_b32 v3, s42
  buffer_store_dword v3, v2, s[24:27], 0 offen sc0 sc1
  s_nop 0
L_noep_61:
L_END:
  s_endpgm
.section .rodata,"a"
.p2align 6
.amdhsa_kernel adaLN_cond__sliding_block__glu_gated_geglu__prompt_kernel
  .amdhsa_next_free_vgpr 256
  .amdhsa_next_free_sgpr 102
  .amdhsa_accum_offset 256
  .amdhsa_group_segment_fixed_size 0
  .amdhsa_kernarg_size 96
  .amdhsa_user_sgpr_count 2
  .amdhsa_user_sgpr_kernarg_segment_ptr 1
  .amdhsa_system_sgpr_workgroup_id_x 1
.end_amdhsa_kernel
```
